```python
import torch

def _softmax(x, axis=-1):
    return torch.softmax(x, dim=axis)
def _gelu(x):
    return torch.nn.functional.gelu(x, approximate="tanh")
def _silu(x):
    return torch.nn.functional.silu(x)
def _sigmoid(x):
    return torch.sigmoid(x)
def _layernorm(x, axis=-1, eps=1e-5):
    m = x.mean(dim=axis, keepdim=True)
    v = x.var(dim=axis, keepdim=True, unbiased=False)
    return (x - m) / torch.sqrt(v + eps)
def _scatter_add(tgt, idx, src, axis=0):
    return tgt.clone().index_add_(axis, idx, src)
def _segment_sum(src, seg, n):
    out = torch.zeros((n,) + src.shape[1:], dtype=src.dtype)
    return out.index_add_(0, seg, src)
def _pad(x, pw):
    flat = tuple(v for pair in reversed(pw) for v in pair)
    return torch.nn.functional.pad(x, flat)

kernel_name = 'parallel_sum__ssm_conv_h3__glu_gated_bilinear__prompt'

def setup_inputs():

    _w = (lambda a: (lambda t: t.to(torch.bfloat16) if t.is_floating_point() else t)(torch.as_tensor(a)))
    def _A_setup():
        B, S, D = 1, 2048, 512
        ks = 4
        return {
            "q": _w((lambda *s: torch.randn(*s, dtype=torch.bfloat16) * 0.05)(B, S, D)),
            "k": _w((lambda *s: torch.randn(*s, dtype=torch.bfloat16) * 0.2)(B, S, D)),
            "v": _w((lambda *s: torch.randn(*s, dtype=torch.bfloat16) * 0.2)(B, S, D)),
            "shift_k": _w((lambda *s: torch.randn(*s, dtype=torch.bfloat16) * 0.2)(D, ks) * 0.5),
            "ssm_k": _w((lambda *s: torch.randn(*s, dtype=torch.bfloat16) * 0.4)(D, S) * (1.0 / S ** 0.5)),
            "ssm_D": _w((lambda *s: torch.randn(*s, dtype=torch.bfloat16) * 0.2)(D)),
        }
    _A_in = _A_setup()

    def _B_setup():
        B, S, D, F = 1, 2048, 512, 1376
        return {
            "x": _w((lambda *s: torch.randn(*s, dtype=torch.bfloat16) * 0.05)(B, S, D)),
            "w_gate": _w((lambda *s: torch.randn(*s, dtype=torch.bfloat16) * 0.2)(D, F) * (D ** -0.5)),
            "w_up": _w((lambda *s: torch.randn(*s, dtype=torch.bfloat16) * 0.2)(D, F) * (D ** -0.5)),
            "w_down": _w((lambda *s: torch.randn(*s, dtype=torch.bfloat16) * 0.2)(F, D) * (F ** -0.5)),
        }
    _B_in = _B_setup()

    return {
        "A_q": _A_in["q"],
        "A_k": _A_in["k"],
        "A_v": _A_in["v"],
        "A_shift_k": _A_in["shift_k"],
        "A_ssm_k": _A_in["ssm_k"],
        "A_ssm_D": _A_in["ssm_D"],
        "B_x": _B_in["x"],
        "B_w_gate": _B_in["w_gate"],
        "B_w_up": _B_in["w_up"],
        "B_w_down": _B_in["w_down"],
    }

def reference(A_q, A_k, A_v, A_shift_k, A_ssm_k, A_ssm_D, B_x, B_w_gate, B_w_up, B_w_down):
    def _A_ref(q, k, v, shift_k, ssm_k, ssm_D):
        B, S, D = q.shape
        ks = shift_k.shape[-1]
        k_pad = _pad(k, ((0, 0), (ks - 1, 0), (0, 0)))
        k_shift = torch.zeros_like(k)
        for t in range(ks):
            k_shift = k_shift + k_pad[:, t:t + S, :] * shift_k[:, ks - 1 - t][None, None, :]
        kv = k_shift * v
        L = 2 * S
        kv_pad = _pad(kv, ((0, 0), (0, S), (0, 0)))
        kf_pad = _pad(ssm_k, ((0, 0), (0, S)))
        kv_f = (lambda x, axes=(-2,-1): torch.fft.rfft2(x.float(), dim=axes))(kv_pad[:, None, :, :], axes=(1, 2))
        kf_f = (lambda x, axes=(-2,-1): torch.fft.rfft2(x.float(), dim=axes))(kf_pad[:, None, :], axes=(1, 2))
        kf_f = (lambda x, *d: x.permute(*d))(kf_f, 1, 2, 0)
        y_f = kv_f * kf_f[None, :, :, :]
        y = (lambda x, s, axes=(-2,-1): torch.fft.irfft2(x, s=s, dim=axes).to(torch.bfloat16))(y_f, (1, L), axes=(1, 2))[:, 0, :S, :]
        y = y + kv * ssm_D[None, None, :]
        return q * y

    def _B_ref(x, w_gate, w_up, w_down):
        g = torch.einsum("bsd,df->bsf", x, w_gate)
        u = torch.einsum("bsd,df->bsf", x, w_up)
        h = g * u
        return torch.einsum("bsf,fd->bsd", h, w_down)

    x = A_q
    xn = _layernorm(x, axis=-1)
    return x + _A_ref(xn, A_k, A_v, A_shift_k, A_ssm_k, A_ssm_D) + _B_ref(xn, B_w_gate, B_w_up, B_w_down)
```

```asm
; @launch kernel=k1_kernel grid=(256,1,1) block=(512,1,1) lds=163840
.amdgcn_target "amdgcn-amd-amdhsa--gfx950"
.text
    .globl k1_kernel
    .p2align 8
    .type k1_kernel,@function
k1_kernel:
    s_cmp_ge_u32 s2, 256
    s_cbranch_scc1 k1_done
    s_load_dwordx16 s[16:31], s[0:1], 0
    s_load_dwordx8 s[32:39], s[0:1], 64
    s_load_dwordx2 s[40:41], s[0:1], 96
    s_mov_b32 s75, 0
    s_cmp_lt_u32 s2, 64
    s_cbranch_scc1 k1_conv
    s_cmp_lt_u32 s2, 240
    s_cbranch_scc1 k1_gemm
k1_aux:
    v_lshrrev_b32 v2, 6, v0
    v_and_b32 v1, 63, v0
    v_readfirstlane_b32 s62, v2
    s_and_b32 s65, s2, 7
    s_bfe_u32 s66, s2, 0x10003
    v_lshrrev_b32 v2, 3, v1
    v_and_b32 v3, 7, v1
    v_lshlrev_b32 v3, 4, v3
    v_lshl_add_u32 v2, v2, 10, v3
    s_mul_i32 s67, s62, 12288
    s_mul_i32 s64, s66, 43
    s_add_u32 s63, s62, 0
    s_min_u32 s63, s63, 42
    s_add_u32 s68, s63, s64
    s_add_u32 s63, s62, 8
    s_min_u32 s63, s63, 42
    s_add_u32 s69, s63, s64
    s_add_u32 s63, s62, 16
    s_min_u32 s63, s63, 42
    s_add_u32 s70, s63, s64
    s_add_u32 s63, s62, 24
    s_min_u32 s63, s63, 42
    s_add_u32 s71, s63, s64
    s_add_u32 s63, s62, 32
    s_min_u32 s63, s63, 42
    s_add_u32 s72, s63, s64
    s_add_u32 s63, s62, 40
    s_min_u32 s63, s63, 42
    s_add_u32 s73, s63, s64
    s_waitcnt lgkmcnt(0)
    s_mov_b32 s44, s34
    s_and_b32 s45, s35, 0xffff
    s_mov_b32 s46, 1409024
    s_mov_b32 s47, 0x00020000
    s_mov_b32 s56, s40
    s_and_b32 s57, s41, 0xffff
    s_mov_b32 s58, 16777216
    s_mov_b32 s59, 0x00020000
    v_lshlrev_b32 v3, 4, v1
    s_cmp_lg_u32 s2, 240
    s_cbranch_scc1 aux_nz0
    s_lshl_b32 s3, s62, 13
    s_add_u32 s3, s3, 9437184
    v_mov_b32 v4, 0
    v_mov_b32 v5, 0
    v_mov_b32 v6, 0
    v_mov_b32 v7, 0
    buffer_store_dwordx4 v[4:7], v3, s[56:59], s3 offen sc1
    s_add_u32 s3, s3, 1024
    buffer_store_dwordx4 v[4:7], v3, s[56:59], s3 offen sc1
    s_add_u32 s3, s3, 1024
    buffer_store_dwordx4 v[4:7], v3, s[56:59], s3 offen sc1
    s_add_u32 s3, s3, 1024
    buffer_store_dwordx4 v[4:7], v3, s[56:59], s3 offen sc1
    s_add_u32 s3, s3, 1024
    buffer_store_dwordx4 v[4:7], v3, s[56:59], s3 offen sc1
    s_add_u32 s3, s3, 1024
    buffer_store_dwordx4 v[4:7], v3, s[56:59], s3 offen sc1
    s_add_u32 s3, s3, 1024
    buffer_store_dwordx4 v[4:7], v3, s[56:59], s3 offen sc1
    s_add_u32 s3, s3, 1024
    buffer_store_dwordx4 v[4:7], v3, s[56:59], s3 offen sc1
    s_add_u32 s3, s3, 1024
aux_nz0:
    s_lshl_b32 s64, s65, 7
    s_lshl_b32 s63, s68, 14
    s_add_u32 s63, s63, s64
    s_add_u32 m0, s67, 0
    buffer_load_dwordx4 v2, s[44:47], s63 offen lds
    s_add_u32 m0, s67, 1024
    s_add_u32 s63, s63, 8192
    buffer_load_dwordx4 v2, s[44:47], s63 offen lds
    s_lshl_b32 s63, s69, 14
    s_add_u32 s63, s63, s64
    s_add_u32 m0, s67, 2048
    buffer_load_dwordx4 v2, s[44:47], s63 offen lds
    s_add_u32 m0, s67, 3072
    s_add_u32 s63, s63, 8192
    buffer_load_dwordx4 v2, s[44:47], s63 offen lds
    s_lshl_b32 s63, s70, 14
    s_add_u32 s63, s63, s64
    s_add_u32 m0, s67, 4096
    buffer_load_dwordx4 v2, s[44:47], s63 offen lds
    s_add_u32 m0, s67, 5120
    s_add_u32 s63, s63, 8192
    buffer_load_dwordx4 v2, s[44:47], s63 offen lds
    s_lshl_b32 s63, s71, 14
    s_add_u32 s63, s63, s64
    s_add_u32 m0, s67, 6144
    buffer_load_dwordx4 v2, s[44:47], s63 offen lds
    s_add_u32 m0, s67, 7168
    s_add_u32 s63, s63, 8192
    buffer_load_dwordx4 v2, s[44:47], s63 offen lds
    s_lshl_b32 s63, s72, 14
    s_add_u32 s63, s63, s64
    s_add_u32 m0, s67, 8192
    buffer_load_dwordx4 v2, s[44:47], s63 offen lds
    s_add_u32 m0, s67, 9216
    s_add_u32 s63, s63, 8192
    buffer_load_dwordx4 v2, s[44:47], s63 offen lds
    s_lshl_b32 s63, s73, 14
    s_add_u32 s63, s63, s64
    s_add_u32 m0, s67, 10240
    buffer_load_dwordx4 v2, s[44:47], s63 offen lds
    s_add_u32 m0, s67, 11264
    s_add_u32 s63, s63, 8192
    buffer_load_dwordx4 v2, s[44:47], s63 offen lds
    s_mov_b32 s82, 0
    v_mov_b32 v12, 4
    v_mov_b32 v13, 0
    v_mov_b32 v14, 0
    v_mov_b32 v15, 163328
    ds_write_b96 v15, v[12:14]
    s_cmp_lg_u32 s2, 240
    s_cbranch_scc1 aux_nz
    s_mov_b32 s84, s38
    s_and_b32 s85, s39, 0xffff
    s_mov_b32 s86, 256
    s_mov_b32 s87, 0x00020000
    s_waitcnt vmcnt(12)
    s_barrier
    s_mov_b32 s82, 1
    s_cmp_lg_u32 s62, 0
    s_cbranch_scc1 aux_nz
    v_mov_b32 v14, 1
    v_mov_b32 v15, 16
    s_mov_b64 exec, 1
    buffer_store_dword v14, v15, s[84:87], 0 offen sc1
    s_mov_b64 exec, -1
aux_nz:
    v_and_b32 v4, 15, v1
    v_lshrrev_b32 v5, 2, v4
    v_lshrrev_b32 v6, 5, v1
    v_lshl_add_u32 v5, v6, 2, v5
    v_lshlrev_b32 v5, 7, v5
    v_bfe_u32 v6, v1, 4, 1
    v_lshl_add_u32 v5, v6, 5, v5
    v_and_b32 v4, 3, v4
    v_lshl_add_u32 v5, v4, 3, v5
    v_add_u32 v5, s67, v5
    s_mul_i32 s64, s65, 180224
    s_add_u32 s64, s64, 10485760
    s_waitcnt vmcnt(0)
    s_cmp_eq_u32 s2, 240
    s_cbranch_scc1 aux_z1
    s_load_dword s82, s[38:39], 16
aux_z1:
    ds_read_b64_tr_b16 v[16:17], v5 offset:0
    ds_read_b64_tr_b16 v[18:19], v5 offset:1024
    ds_read_b64_tr_b16 v[20:21], v5 offset:64
    ds_read_b64_tr_b16 v[22:23], v5 offset:1088
    ds_read_b64_tr_b16 v[24:25], v5 offset:2048
    ds_read_b64_tr_b16 v[26:27], v5 offset:3072
    ds_read_b64_tr_b16 v[28:29], v5 offset:2112
    ds_read_b64_tr_b16 v[30:31], v5 offset:3136
    s_waitcnt lgkmcnt(0)
    s_lshl_b32 s63, s68, 11
    s_add_u32 s63, s63, s64
    buffer_store_dwordx4 v[16:19], v3, s[56:59], s63 offen offset:0 sc1
    buffer_store_dwordx4 v[20:23], v3, s[56:59], s63 offen offset:1024 sc1
    ds_read_b64_tr_b16 v[32:33], v5 offset:4096
    ds_read_b64_tr_b16 v[34:35], v5 offset:5120
    ds_read_b64_tr_b16 v[36:37], v5 offset:4160
    ds_read_b64_tr_b16 v[38:39], v5 offset:5184
    s_waitcnt lgkmcnt(4)
    s_lshl_b32 s63, s69, 11
    s_add_u32 s63, s63, s64
    buffer_store_dwordx4 v[24:27], v3, s[56:59], s63 offen offset:0 sc1
    buffer_store_dwordx4 v[28:31], v3, s[56:59], s63 offen offset:1024 sc1
    ds_read_b64_tr_b16 v[40:41], v5 offset:6144
    ds_read_b64_tr_b16 v[42:43], v5 offset:7168
    ds_read_b64_tr_b16 v[44:45], v5 offset:6208
    ds_read_b64_tr_b16 v[46:47], v5 offset:7232
    s_waitcnt lgkmcnt(4)
    s_lshl_b32 s63, s70, 11
    s_add_u32 s63, s63, s64
    buffer_store_dwordx4 v[32:35], v3, s[56:59], s63 offen offset:0 sc1
    buffer_store_dwordx4 v[36:39], v3, s[56:59], s63 offen offset:1024 sc1
    ds_read_b64_tr_b16 v[48:49], v5 offset:8192
    ds_read_b64_tr_b16 v[50:51], v5 offset:9216
    ds_read_b64_tr_b16 v[52:53], v5 offset:8256
    ds_read_b64_tr_b16 v[54:55], v5 offset:9280
    s_waitcnt lgkmcnt(4)
    s_lshl_b32 s63, s71, 11
    s_add_u32 s63, s63, s64
    buffer_store_dwordx4 v[40:43], v3, s[56:59], s63 offen offset:0 sc1
    buffer_store_dwordx4 v[44:47], v3, s[56:59], s63 offen offset:1024 sc1
    ds_read_b64_tr_b16 v[56:57], v5 offset:10240
    ds_read_b64_tr_b16 v[58:59], v5 offset:11264
    ds_read_b64_tr_b16 v[60:61], v5 offset:10304
    ds_read_b64_tr_b16 v[62:63], v5 offset:11328
    s_waitcnt lgkmcnt(4)
    s_lshl_b32 s63, s72, 11
    s_add_u32 s63, s63, s64
    buffer_store_dwordx4 v[48:51], v3, s[56:59], s63 offen offset:0 sc1
    buffer_store_dwordx4 v[52:55], v3, s[56:59], s63 offen offset:1024 sc1
    s_waitcnt lgkmcnt(0)
    s_lshl_b32 s63, s73, 11
    s_add_u32 s63, s63, s64
    buffer_store_dwordx4 v[56:59], v3, s[56:59], s63 offen offset:0 sc1
    buffer_store_dwordx4 v[60:63], v3, s[56:59], s63 offen offset:1024 sc1
    s_cmp_ge_u32 s82, 1
    s_cbranch_scc1 sig_go1
    s_mov_b32 s84, s38
    s_and_b32 s85, s39, 0xffff
    s_mov_b32 s86, 256
    s_mov_b32 s87, 0x00020000
    v_mov_b32 v15, 16
    s_mov_b32 s80, 0
zp1:
    buffer_load_dword v14, v15, s[84:87], 0 offen sc1
    s_waitcnt vmcnt(0)
    v_readfirstlane_b32 s81, v14
    s_nop 3
    s_add_u32 s80, s80, 1
    s_cmp_ge_u32 s81, 1
    s_cbranch_scc1 zd1
    s_sleep 8
    s_cmp_lt_u32 s80, 0x40000
    s_cbranch_scc1 zp1
zd1:
    s_mov_b32 s82, 1
sig_go1:
    s_waitcnt vmcnt(0)
    s_barrier
    s_lshl_b32 s63, s65, 5
    v_add_u32 v4, s63, v1
    v_subrev_u32 v5, 64, v4
    v_cmp_gt_u32 vcc, 176, v5
    v_mov_b32 v5, 22
    v_mov_b32 v6, 88
    v_cndmask_b32 v5, v5, v6, vcc
    v_cmp_gt_u32 vcc, 64, v4
    v_cndmask_b32 v5, v5, 64, vcc
    v_lshl_add_u32 v4, v4, 8, v5
    s_lshl_b32 s63, s65, 3
    s_add_u32 s63, s63, 208
    v_add_u32 v5, s63, v1
    v_lshlrev_b32 v5, 8, v5
    v_add_u32 v5, 64, v5
    v_cmp_gt_u32 vcc, 32, v1
    v_cndmask_b32 v4, v5, v4, vcc
    s_add_u32 s63, s66, 9437184
    v_mov_b32 v5, 1
    s_cmp_lt_u32 s65, 2
    s_cselect_b32 s64, 0xff, 0
    s_cmp_eq_u32 s62, 0
    s_cselect_b32 exec_lo, -1, 0
    s_cselect_b32 exec_hi, s64, 0
    buffer_store_byte v5, v4, s[56:59], s63 offen sc1
    s_mov_b64 exec, -1
    s_mov_b32 s5, 3
    s_cmp_lg_u32 s62, 7
    s_cbranch_scc1 aux_kw
    s_lshl_b32 s4, s2, 8
    s_add_u32 s4, s4, 9437248
    s_mov_b32 s80, 0
poll2:
    buffer_load_ubyte v14, v1, s[56:59], s4 offen sc1
    s_waitcnt vmcnt(0)
    v_cmp_ne_u32 vcc, 0, v14
    s_add_u32 s80, s80, 1
    s_and_b32 s81, vcc_lo, s5
    s_cmp_eq_u32 s81, s5
    s_cbranch_scc1 polled2
    s_sleep 1
    s_cmp_lt_u32 s80, 0x40000
    s_cbranch_scc1 poll2
polled2:
    v_mov_b32 v14, 163328
    v_mov_b32 v15, -1
    ds_write_b32 v14, v15 offset:8
    s_branch aux_kd
aux_kw:
    v_mov_b32 v14, 163328
    s_mov_b32 s80, 0
lw3:
    ds_read_b32 v15, v14 offset:8
    s_waitcnt lgkmcnt(0)
    v_readfirstlane_b32 s81, v15
    s_add_u32 s80, s80, 1
    s_nop 2
    s_and_b32 s81, s81, s5
    s_cmp_eq_u32 s81, s5
    s_cbranch_scc1 lwd3
    s_sleep 1
    s_cmp_lt_u32 s80, 0x1000000
    s_cbranch_scc1 lw3
lwd3:
aux_kd:
    s_mul_i32 s63, s66, 180224
    s_mul_i32 s64, s62, 22528
    s_add_u32 s63, s63, s64
    s_add_u32 s63, s63, 10485760
    buffer_load_dwordx4 v[80:83], v3, s[56:59], s63 offen offset:0
    buffer_load_dwordx4 v[84:87], v3, s[56:59], s63 offen offset:1024
    buffer_load_dwordx4 v[88:91], v3, s[56:59], s63 offen offset:2048
    buffer_load_dwordx4 v[92:95], v3, s[56:59], s63 offen offset:3072
    s_add_u32 s63, s63, 4096
    buffer_load_dwordx4 v[96:99], v3, s[56:59], s63 offen offset:0
    buffer_load_dwordx4 v[100:103], v3, s[56:59], s63 offen offset:1024
    buffer_load_dwordx4 v[104:107], v3, s[56:59], s63 offen offset:2048
    buffer_load_dwordx4 v[108:111], v3, s[56:59], s63 offen offset:3072
    s_add_u32 s63, s63, 4096
    buffer_load_dwordx4 v[112:115], v3, s[56:59], s63 offen offset:0
    buffer_load_dwordx4 v[116:119], v3, s[56:59], s63 offen offset:1024
    buffer_load_dwordx4 v[120:123], v3, s[56:59], s63 offen offset:2048
    buffer_load_dwordx4 v[124:127], v3, s[56:59], s63 offen offset:3072
    s_add_u32 s63, s63, 4096
    buffer_load_dwordx4 v[128:131], v3, s[56:59], s63 offen offset:0
    buffer_load_dwordx4 v[132:135], v3, s[56:59], s63 offen offset:1024
    buffer_load_dwordx4 v[136:139], v3, s[56:59], s63 offen offset:2048
    buffer_load_dwordx4 v[140:143], v3, s[56:59], s63 offen offset:3072
    s_add_u32 s63, s63, 4096
    buffer_load_dwordx4 v[144:147], v3, s[56:59], s63 offen offset:0
    buffer_load_dwordx4 v[148:151], v3, s[56:59], s63 offen offset:1024
    buffer_load_dwordx4 v[152:155], v3, s[56:59], s63 offen offset:2048
    buffer_load_dwordx4 v[156:159], v3, s[56:59], s63 offen offset:3072
    s_add_u32 s63, s63, 4096
    buffer_load_dwordx4 v[160:163], v3, s[56:59], s63 offen offset:0
    buffer_load_dwordx4 v[164:167], v3, s[56:59], s63 offen offset:1024
    s_mov_b32 s42, 0
    s_mov_b32 s78, 9437184
    s_mov_b32 s79, 0
    s_mov_b32 s43, 12582912
    s_mov_b32 s76, 1
    s_mov_b32 s77, 0
    s_branch g2_unit
k1_gemm:
    s_sub_u32 s3, s2, 64
    s_and_b32 s4, s3, 7
    s_mul_i32 s4, s4, 22
    s_lshr_b32 s5, s3, 3
    s_add_u32 s4, s4, s5
    s_cmp_ge_u32 s4, 88
    s_cselect_b32 s5, 88, 0
    s_cselect_b32 s60, 8, 0
    s_sub_u32 s4, s4, s5
    s_lshr_b32 s61, s4, 3
    s_and_b32 s4, s4, 7
    s_add_u32 s60, s60, s4
    v_lshrrev_b32 v2, 6, v0
    v_and_b32 v1, 63, v0
    v_readfirstlane_b32 s62, v2
    s_nop 3
    s_cmp_ge_u32 s62, 4
    s_cbranch_scc1 k1_help
    s_and_b32 s65, s62, 1
    s_lshr_b32 s66, s62, 1
    s_lshl_b32 s63, s65, 6
    v_and_b32 v2, 31, v1
    v_add_u32 v6, s63, v2
    v_lshrrev_b32 v7, 1, v2
    v_and_b32 v7, 7, v7
    v_lshrrev_b32 v8, 5, v1
    v_xor_b32 v7, v7, v8
    v_lshlrev_b32 v7, 4, v7
    v_lshl_add_u32 v7, v6, 7, v7
    v_add_u32 v10, 32768, v7
    v_lshlrev_b32 v9, 2, v6
    v_add_u32 v9, 159744, v9
    v_and_b32 v2, 15, v1
    v_lshrrev_b32 v6, 2, v2
    v_lshrrev_b32 v7, 5, v1
    v_lshl_add_u32 v7, v7, 3, v6
    v_lshlrev_b32 v7, 8, v7
    v_lshrrev_b32 v8, 4, v1
    v_and_b32 v8, 1, v8
    v_lshlrev_b32 v8, 5, v8
    v_add_u32 v7, v7, v8
    v_and_b32 v8, 3, v2
    v_lshlrev_b32 v8, 3, v8
    v_add_u32 v7, v7, v8
    s_lshl_b32 s63, s66, 1
    v_xor_b32 v8, s63, v6
    v_lshl_add_u32 v11, v8, 6, v7
    v_xor_b32 v8, 1, v8
    v_lshl_add_u32 v12, v8, 6, v7
    v_add_u32 v192, 0, v11
    v_add_u32 v193, 0, v12
    v_add_u32 v194, 0, v10
    v_xor_b32 v195, 32, v194
    v_xor_b32 v196, 64, v194
    v_xor_b32 v197, 96, v194
    v_add_u32 v198, 49152, v11
    v_add_u32 v199, 49152, v12
    v_add_u32 v200, 49152, v10
    v_xor_b32 v201, 32, v200
    v_xor_b32 v202, 64, v200
    v_xor_b32 v203, 96, v200
    v_add_u32 v204, 98304, v11
    v_add_u32 v205, 98304, v12
    v_add_u32 v206, 98304, v10
    v_xor_b32 v207, 32, v206
    v_xor_b32 v208, 64, v206
    v_xor_b32 v209, 96, v206
    v_lshlrev_b32 v210, 4, v1
    s_lshl_b32 s63, s66, 11
    s_add_u32 s63, s63, 147456
    v_add_u32 v10, s63, v210
    s_lshl_b32 s63, s65, 11
    s_add_u32 s63, s63, 155648
    v_add_u32 v11, s63, v210
    s_lshl_b32 s63, s60, 1
    s_add_u32 s63, s63, s65
    s_mul_i32 s67, s63, 180224
    s_lshl_b32 s64, s61, 1
    s_add_u32 s64, s64, s66
    s_and_b32 s3, s63, 3
    s_lshl_b32 s3, s3, 3
    s_lshr_b32 s78, s63, 2
    s_add_u32 s78, s78, s3
    s_lshl_b32 s78, s78, 8
    s_add_u32 s78, s78, s64
    s_add_u32 s78, s78, 9437184
    s_mov_b32 s79, 13
    s_lshl_b32 s64, s64, 12
    s_add_u32 s67, s67, s64
    s_mov_b32 s42, 0xff
    s_mov_b32 s43, 0
    s_mov_b32 s76, 1
    s_mov_b32 s77, 0
    v_mov_b32 v14, 163328
    v_mov_b32 v15, 1
    s_waitcnt lgkmcnt(0)
    s_mov_b32 s56, s40
    s_and_b32 s57, s41, 0xffff
    s_mov_b32 s58, 16777216
    s_mov_b32 s59, 0x00020000
    s_barrier
    ds_read_b128 v[16:19], v194 offset:0
    ds_read_b64_tr_b16 v[32:33], v192 offset:0
    ds_read_b64_tr_b16 v[34:35], v192 offset:1024
    ds_read_b64_tr_b16 v[36:37], v193 offset:0
    ds_read_b64_tr_b16 v[38:39], v193 offset:1024
    ds_read_b64_tr_b16 v[40:41], v192 offset:16384
    ds_read_b64_tr_b16 v[42:43], v192 offset:17408
    ds_read_b64_tr_b16 v[44:45], v193 offset:16384
    ds_read_b64_tr_b16 v[46:47], v193 offset:17408
    ds_read_b128 v[20:23], v194 offset:4096
    s_waitcnt lgkmcnt(7)
    v_mfma_f32_32x32x16_bf16 v[64:79], v[32:35], v[16:19], 0
    ds_read_b128 v[24:27], v195 offset:0
    ds_read_b64_tr_b16 v[48:49], v192 offset:4096
    s_waitcnt lgkmcnt(7)
    v_mfma_f32_32x32x16_bf16 v[80:95], v[36:39], v[16:19], 0
    ds_read_b64_tr_b16 v[50:51], v192 offset:5120
    ds_read_b64_tr_b16 v[52:53], v193 offset:4096
    s_waitcnt lgkmcnt(7)
    v_mfma_f32_32x32x16_bf16 v[96:111], v[40:43], v[16:19], 0
    ds_read_b64_tr_b16 v[54:55], v193 offset:5120
    ds_read_b64_tr_b16 v[56:57], v192 offset:20480
    s_waitcnt lgkmcnt(7)
    v_mfma_f32_32x32x16_bf16 v[112:127], v[44:47], v[16:19], 0
    ds_read_b64_tr_b16 v[58:59], v192 offset:21504
    ds_read_b64_tr_b16 v[60:61], v193 offset:20480
    s_waitcnt lgkmcnt(8)
    v_mfma_f32_32x32x16_bf16 v[128:143], v[32:35], v[20:23], 0
    ds_read_b64_tr_b16 v[62:63], v193 offset:21504
    ds_read_b128 v[28:31], v195 offset:4096
    v_mfma_f32_32x32x16_bf16 v[144:159], v[36:39], v[20:23], 0
    ds_read_b128 v[16:19], v196 offset:0
    ds_read_b64_tr_b16 v[32:33], v192 offset:8192
    v_mfma_f32_32x32x16_bf16 v[160:175], v[40:43], v[20:23], 0
    ds_read_b64_tr_b16 v[34:35], v192 offset:9216
    ds_read_b64_tr_b16 v[36:37], v193 offset:8192
    v_mfma_f32_32x32x16_bf16 v[176:191], v[44:47], v[20:23], 0
    s_waitcnt lgkmcnt(11)
    v_mfma_f32_32x32x16_bf16 v[64:79], v[48:51], v[24:27], v[64:79]
    ds_read_b64_tr_b16 v[38:39], v193 offset:9216
    ds_read_b64_tr_b16 v[40:41], v192 offset:24576
    s_waitcnt lgkmcnt(11)
    v_mfma_f32_32x32x16_bf16 v[80:95], v[52:55], v[24:27], v[80:95]
    ds_read_b64_tr_b16 v[42:43], v192 offset:25600
    ds_read_b64_tr_b16 v[44:45], v193 offset:24576
    s_waitcnt lgkmcnt(11)
    v_mfma_f32_32x32x16_bf16 v[96:111], v[56:59], v[24:27], v[96:111]
    ds_read_b64_tr_b16 v[46:47], v193 offset:25600
    ds_read_b128 v[20:23], v196 offset:4096
    s_waitcnt lgkmcnt(11)
    v_mfma_f32_32x32x16_bf16 v[112:127], v[60:63], v[24:27], v[112:127]
    ds_read_b128 v[24:27], v197 offset:0
    s_waitcnt lgkmcnt(11)
    v_mfma_f32_32x32x16_bf16 v[128:143], v[48:51], v[28:31], v[128:143]
    ds_read_b64_tr_b16 v[48:49], v192 offset:12288
    ds_read_b64_tr_b16 v[50:51], v192 offset:13312
    v_mfma_f32_32x32x16_bf16 v[144:159], v[52:55], v[28:31], v[144:159]
    ds_read_b64_tr_b16 v[52:53], v193 offset:12288
    v_mfma_f32_32x32x16_bf16 v[160:175], v[56:59], v[28:31], v[160:175]
    v_mfma_f32_32x32x16_bf16 v[176:191], v[60:63], v[28:31], v[176:191]
    s_waitcnt lgkmcnt(11)
    v_mfma_f32_32x32x16_bf16 v[64:79], v[32:35], v[16:19], v[64:79]
    ds_read_b64_tr_b16 v[54:55], v193 offset:13312
    ds_read_b64_tr_b16 v[56:57], v192 offset:28672
    s_waitcnt lgkmcnt(11)
    v_mfma_f32_32x32x16_bf16 v[80:95], v[36:39], v[16:19], v[80:95]
    ds_read_b64_tr_b16 v[58:59], v192 offset:29696
    ds_read_b64_tr_b16 v[60:61], v193 offset:28672
    s_waitcnt lgkmcnt(11)
    v_mfma_f32_32x32x16_bf16 v[96:111], v[40:43], v[16:19], v[96:111]
    ds_read_b64_tr_b16 v[62:63], v193 offset:29696
    ds_read_b128 v[28:31], v197 offset:4096
    s_waitcnt lgkmcnt(11)
    v_mfma_f32_32x32x16_bf16 v[112:127], v[44:47], v[16:19], v[112:127]
    s_waitcnt lgkmcnt(10)
    v_mfma_f32_32x32x16_bf16 v[128:143], v[32:35], v[20:23], v[128:143]
    v_mfma_f32_32x32x16_bf16 v[144:159], v[36:39], v[20:23], v[144:159]
    v_mfma_f32_32x32x16_bf16 v[160:175], v[40:43], v[20:23], v[160:175]
    v_mfma_f32_32x32x16_bf16 v[176:191], v[44:47], v[20:23], v[176:191]
    s_waitcnt lgkmcnt(7)
    v_mfma_f32_32x32x16_bf16 v[64:79], v[48:51], v[24:27], v[64:79]
    s_waitcnt lgkmcnt(0)
    s_barrier
    ds_read_b128 v[16:19], v200 offset:0
    ds_read_b64_tr_b16 v[32:33], v198 offset:0
    v_mfma_f32_32x32x16_bf16 v[80:95], v[52:55], v[24:27], v[80:95]
    ds_read_b64_tr_b16 v[34:35], v198 offset:1024
    ds_read_b64_tr_b16 v[36:37], v199 offset:0
    v_mfma_f32_32x32x16_bf16 v[96:111], v[56:59], v[24:27], v[96:111]
    ds_read_b64_tr_b16 v[38:39], v199 offset:1024
    ds_read_b64_tr_b16 v[40:41], v198 offset:16384
    v_mfma_f32_32x32x16_bf16 v[112:127], v[60:63], v[24:27], v[112:127]
    ds_read_b64_tr_b16 v[42:43], v198 offset:17408
    ds_read_b64_tr_b16 v[44:45], v199 offset:16384
    v_mfma_f32_32x32x16_bf16 v[128:143], v[48:51], v[28:31], v[128:143]
    ds_read_b64_tr_b16 v[46:47], v199 offset:17408
    ds_read_b128 v[20:23], v200 offset:4096
    v_mfma_f32_32x32x16_bf16 v[144:159], v[52:55], v[28:31], v[144:159]
    ds_read_b128 v[24:27], v201 offset:0
    ds_read_b64_tr_b16 v[48:49], v198 offset:4096
    v_mfma_f32_32x32x16_bf16 v[160:175], v[56:59], v[28:31], v[160:175]
    ds_read_b64_tr_b16 v[50:51], v198 offset:5120
    ds_read_b64_tr_b16 v[52:53], v199 offset:4096
    v_mfma_f32_32x32x16_bf16 v[176:191], v[60:63], v[28:31], v[176:191]
    s_waitcnt lgkmcnt(11)
    v_mfma_f32_32x32x16_bf16 v[64:79], v[32:35], v[16:19], v[64:79]
    ds_read_b64_tr_b16 v[54:55], v199 offset:5120
    ds_read_b64_tr_b16 v[56:57], v198 offset:20480
    s_waitcnt lgkmcnt(11)
    v_mfma_f32_32x32x16_bf16 v[80:95], v[36:39], v[16:19], v[80:95]
    ds_read_b64_tr_b16 v[58:59], v198 offset:21504
    ds_read_b64_tr_b16 v[60:61], v199 offset:20480
    s_waitcnt lgkmcnt(11)
    v_mfma_f32_32x32x16_bf16 v[96:111], v[40:43], v[16:19], v[96:111]
    ds_read_b64_tr_b16 v[62:63], v199 offset:21504
    ds_read_b128 v[28:31], v201 offset:4096
    s_waitcnt lgkmcnt(11)
    v_mfma_f32_32x32x16_bf16 v[112:127], v[44:47], v[16:19], v[112:127]
    ds_read_b128 v[16:19], v202 offset:0
    s_waitcnt lgkmcnt(11)
    v_mfma_f32_32x32x16_bf16 v[128:143], v[32:35], v[20:23], v[128:143]
    ds_read_b64_tr_b16 v[32:33], v198 offset:8192
    ds_read_b64_tr_b16 v[34:35], v198 offset:9216
    v_mfma_f32_32x32x16_bf16 v[144:159], v[36:39], v[20:23], v[144:159]
    ds_read_b64_tr_b16 v[36:37], v199 offset:8192
    v_mfma_f32_32x32x16_bf16 v[160:175], v[40:43], v[20:23], v[160:175]
    v_mfma_f32_32x32x16_bf16 v[176:191], v[44:47], v[20:23], v[176:191]
    s_waitcnt lgkmcnt(11)
    v_mfma_f32_32x32x16_bf16 v[64:79], v[48:51], v[24:27], v[64:79]
    ds_read_b64_tr_b16 v[38:39], v199 offset:9216
    ds_read_b64_tr_b16 v[40:41], v198 offset:24576
    s_waitcnt lgkmcnt(11)
    v_mfma_f32_32x32x16_bf16 v[80:95], v[52:55], v[24:27], v[80:95]
    ds_read_b64_tr_b16 v[42:43], v198 offset:25600
    ds_read_b64_tr_b16 v[44:45], v199 offset:24576
    s_waitcnt lgkmcnt(11)
    v_mfma_f32_32x32x16_bf16 v[96:111], v[56:59], v[24:27], v[96:111]
    ds_read_b64_tr_b16 v[46:47], v199 offset:25600
    ds_read_b128 v[20:23], v202 offset:4096
    s_waitcnt lgkmcnt(11)
    v_mfma_f32_32x32x16_bf16 v[112:127], v[60:63], v[24:27], v[112:127]
    ds_read_b128 v[24:27], v203 offset:0
    s_waitcnt lgkmcnt(11)
    v_mfma_f32_32x32x16_bf16 v[128:143], v[48:51], v[28:31], v[128:143]
    ds_read_b64_tr_b16 v[48:49], v198 offset:12288
    ds_read_b64_tr_b16 v[50:51], v198 offset:13312
    v_mfma_f32_32x32x16_bf16 v[144:159], v[52:55], v[28:31], v[144:159]
    ds_read_b64_tr_b16 v[52:53], v199 offset:12288
    v_mfma_f32_32x32x16_bf16 v[160:175], v[56:59], v[28:31], v[160:175]
    v_mfma_f32_32x32x16_bf16 v[176:191], v[60:63], v[28:31], v[176:191]
    s_waitcnt lgkmcnt(11)
    v_mfma_f32_32x32x16_bf16 v[64:79], v[32:35], v[16:19], v[64:79]
    ds_read_b64_tr_b16 v[54:55], v199 offset:13312
    ds_read_b64_tr_b16 v[56:57], v198 offset:28672
    s_waitcnt lgkmcnt(11)
    v_mfma_f32_32x32x16_bf16 v[80:95], v[36:39], v[16:19], v[80:95]
    ds_read_b64_tr_b16 v[58:59], v198 offset:29696
    ds_read_b64_tr_b16 v[60:61], v199 offset:28672
    s_waitcnt lgkmcnt(11)
    v_mfma_f32_32x32x16_bf16 v[96:111], v[40:43], v[16:19], v[96:111]
    ds_read_b64_tr_b16 v[62:63], v199 offset:29696
    ds_read_b128 v[28:31], v203 offset:4096
    s_waitcnt lgkmcnt(11)
    v_mfma_f32_32x32x16_bf16 v[112:127], v[44:47], v[16:19], v[112:127]
    s_waitcnt lgkmcnt(10)
    v_mfma_f32_32x32x16_bf16 v[128:143], v[32:35], v[20:23], v[128:143]
    v_mfma_f32_32x32x16_bf16 v[144:159], v[36:39], v[20:23], v[144:159]
    v_mfma_f32_32x32x16_bf16 v[160:175], v[40:43], v[20:23], v[160:175]
    v_mfma_f32_32x32x16_bf16 v[176:191], v[44:47], v[20:23], v[176:191]
    s_waitcnt lgkmcnt(7)
    v_mfma_f32_32x32x16_bf16 v[64:79], v[48:51], v[24:27], v[64:79]
    s_waitcnt lgkmcnt(0)
    s_barrier
    ds_read_b128 v[16:19], v206 offset:0
    ds_read_b64_tr_b16 v[32:33], v204 offset:0
    v_mfma_f32_32x32x16_bf16 v[80:95], v[52:55], v[24:27], v[80:95]
    ds_read_b64_tr_b16 v[34:35], v204 offset:1024
    ds_read_b64_tr_b16 v[36:37], v205 offset:0
    v_mfma_f32_32x32x16_bf16 v[96:111], v[56:59], v[24:27], v[96:111]
    ds_read_b64_tr_b16 v[38:39], v205 offset:1024
    ds_read_b64_tr_b16 v[40:41], v204 offset:16384
    v_mfma_f32_32x32x16_bf16 v[112:127], v[60:63], v[24:27], v[112:127]
    ds_read_b64_tr_b16 v[42:43], v204 offset:17408
    ds_read_b64_tr_b16 v[44:45], v205 offset:16384
    v_mfma_f32_32x32x16_bf16 v[128:143], v[48:51], v[28:31], v[128:143]
    ds_read_b64_tr_b16 v[46:47], v205 offset:17408
    ds_read_b128 v[20:23], v206 offset:4096
    v_mfma_f32_32x32x16_bf16 v[144:159], v[52:55], v[28:31], v[144:159]
    ds_read_b128 v[24:27], v207 offset:0
    ds_read_b64_tr_b16 v[48:49], v204 offset:4096
    v_mfma_f32_32x32x16_bf16 v[160:175], v[56:59], v[28:31], v[160:175]
    ds_read_b64_tr_b16 v[50:51], v204 offset:5120
    ds_read_b64_tr_b16 v[52:53], v205 offset:4096
    v_mfma_f32_32x32x16_bf16 v[176:191], v[60:63], v[28:31], v[176:191]
    s_waitcnt lgkmcnt(11)
    v_mfma_f32_32x32x16_bf16 v[64:79], v[32:35], v[16:19], v[64:79]
    ds_read_b64_tr_b16 v[54:55], v205 offset:5120
    ds_read_b64_tr_b16 v[56:57], v204 offset:20480
    s_waitcnt lgkmcnt(11)
    v_mfma_f32_32x32x16_bf16 v[80:95], v[36:39], v[16:19], v[80:95]
    ds_read_b64_tr_b16 v[58:59], v204 offset:21504
    ds_read_b64_tr_b16 v[60:61], v205 offset:20480
    s_waitcnt lgkmcnt(11)
    v_mfma_f32_32x32x16_bf16 v[96:111], v[40:43], v[16:19], v[96:111]
    ds_read_b64_tr_b16 v[62:63], v205 offset:21504
    ds_read_b128 v[28:31], v207 offset:4096
    s_waitcnt lgkmcnt(11)
    v_mfma_f32_32x32x16_bf16 v[112:127], v[44:47], v[16:19], v[112:127]
    ds_read_b128 v[16:19], v208 offset:0
    s_waitcnt lgkmcnt(11)
    v_mfma_f32_32x32x16_bf16 v[128:143], v[32:35], v[20:23], v[128:143]
    ds_read_b64_tr_b16 v[32:33], v204 offset:8192
    ds_read_b64_tr_b16 v[34:35], v204 offset:9216
    v_mfma_f32_32x32x16_bf16 v[144:159], v[36:39], v[20:23], v[144:159]
    ds_read_b64_tr_b16 v[36:37], v205 offset:8192
    v_mfma_f32_32x32x16_bf16 v[160:175], v[40:43], v[20:23], v[160:175]
    v_mfma_f32_32x32x16_bf16 v[176:191], v[44:47], v[20:23], v[176:191]
    s_waitcnt lgkmcnt(11)
    v_mfma_f32_32x32x16_bf16 v[64:79], v[48:51], v[24:27], v[64:79]
    ds_read_b64_tr_b16 v[38:39], v205 offset:9216
    ds_read_b64_tr_b16 v[40:41], v204 offset:24576
    s_waitcnt lgkmcnt(11)
    v_mfma_f32_32x32x16_bf16 v[80:95], v[52:55], v[24:27], v[80:95]
    ds_read_b64_tr_b16 v[42:43], v204 offset:25600
    ds_read_b64_tr_b16 v[44:45], v205 offset:24576
    s_waitcnt lgkmcnt(11)
    v_mfma_f32_32x32x16_bf16 v[96:111], v[56:59], v[24:27], v[96:111]
    ds_read_b64_tr_b16 v[46:47], v205 offset:25600
    ds_read_b128 v[20:23], v208 offset:4096
    s_waitcnt lgkmcnt(11)
    v_mfma_f32_32x32x16_bf16 v[112:127], v[60:63], v[24:27], v[112:127]
    ds_read_b128 v[24:27], v209 offset:0
    s_waitcnt lgkmcnt(11)
    v_mfma_f32_32x32x16_bf16 v[128:143], v[48:51], v[28:31], v[128:143]
    ds_read_b64_tr_b16 v[48:49], v204 offset:12288
    ds_read_b64_tr_b16 v[50:51], v204 offset:13312
    v_mfma_f32_32x32x16_bf16 v[144:159], v[52:55], v[28:31], v[144:159]
    ds_read_b64_tr_b16 v[52:53], v205 offset:12288
    v_mfma_f32_32x32x16_bf16 v[160:175], v[56:59], v[28:31], v[160:175]
    v_mfma_f32_32x32x16_bf16 v[176:191], v[60:63], v[28:31], v[176:191]
    s_waitcnt lgkmcnt(11)
    v_mfma_f32_32x32x16_bf16 v[64:79], v[32:35], v[16:19], v[64:79]
    ds_read_b64_tr_b16 v[54:55], v205 offset:13312
    ds_read_b64_tr_b16 v[56:57], v204 offset:28672
    s_waitcnt lgkmcnt(11)
    v_mfma_f32_32x32x16_bf16 v[80:95], v[36:39], v[16:19], v[80:95]
    ds_read_b64_tr_b16 v[58:59], v204 offset:29696
    ds_read_b64_tr_b16 v[60:61], v205 offset:28672
    s_waitcnt lgkmcnt(11)
    v_mfma_f32_32x32x16_bf16 v[96:111], v[40:43], v[16:19], v[96:111]
    ds_read_b64_tr_b16 v[62:63], v205 offset:29696
    ds_read_b128 v[28:31], v209 offset:4096
    s_waitcnt lgkmcnt(11)
    v_mfma_f32_32x32x16_bf16 v[112:127], v[44:47], v[16:19], v[112:127]
    s_waitcnt lgkmcnt(10)
    v_mfma_f32_32x32x16_bf16 v[128:143], v[32:35], v[20:23], v[128:143]
    v_mfma_f32_32x32x16_bf16 v[144:159], v[36:39], v[20:23], v[144:159]
    v_mfma_f32_32x32x16_bf16 v[160:175], v[40:43], v[20:23], v[160:175]
    v_mfma_f32_32x32x16_bf16 v[176:191], v[44:47], v[20:23], v[176:191]
    s_waitcnt lgkmcnt(7)
    v_mfma_f32_32x32x16_bf16 v[64:79], v[48:51], v[24:27], v[64:79]
    s_waitcnt lgkmcnt(0)
    s_barrier
    ds_read_b128 v[16:19], v194 offset:0
    ds_read_b64_tr_b16 v[32:33], v192 offset:0
    v_mfma_f32_32x32x16_bf16 v[80:95], v[52:55], v[24:27], v[80:95]
    ds_read_b64_tr_b16 v[34:35], v192 offset:1024
    ds_read_b64_tr_b16 v[36:37], v193 offset:0
    v_mfma_f32_32x32x16_bf16 v[96:111], v[56:59], v[24:27], v[96:111]
    ds_read_b64_tr_b16 v[38:39], v193 offset:1024
    ds_read_b64_tr_b16 v[40:41], v192 offset:16384
    v_mfma_f32_32x32x16_bf16 v[112:127], v[60:63], v[24:27], v[112:127]
    ds_read_b64_tr_b16 v[42:43], v192 offset:17408
    ds_read_b64_tr_b16 v[44:45], v193 offset:16384
    v_mfma_f32_32x32x16_bf16 v[128:143], v[48:51], v[28:31], v[128:143]
    ds_read_b64_tr_b16 v[46:47], v193 offset:17408
    ds_read_b128 v[20:23], v194 offset:4096
    v_mfma_f32_32x32x16_bf16 v[144:159], v[52:55], v[28:31], v[144:159]
    ds_read_b128 v[24:27], v195 offset:0
    ds_read_b64_tr_b16 v[48:49], v192 offset:4096
    v_mfma_f32_32x32x16_bf16 v[160:175], v[56:59], v[28:31], v[160:175]
    ds_read_b64_tr_b16 v[50:51], v192 offset:5120
    ds_read_b64_tr_b16 v[52:53], v193 offset:4096
    v_mfma_f32_32x32x16_bf16 v[176:191], v[60:63], v[28:31], v[176:191]
    s_waitcnt lgkmcnt(11)
    v_mfma_f32_32x32x16_bf16 v[64:79], v[32:35], v[16:19], v[64:79]
    ds_read_b64_tr_b16 v[54:55], v193 offset:5120
    ds_read_b64_tr_b16 v[56:57], v192 offset:20480
    s_waitcnt lgkmcnt(11)
    v_mfma_f32_32x32x16_bf16 v[80:95], v[36:39], v[16:19], v[80:95]
    ds_read_b64_tr_b16 v[58:59], v192 offset:21504
    ds_read_b64_tr_b16 v[60:61], v193 offset:20480
    s_waitcnt lgkmcnt(11)
    v_mfma_f32_32x32x16_bf16 v[96:111], v[40:43], v[16:19], v[96:111]
    ds_read_b64_tr_b16 v[62:63], v193 offset:21504
    ds_read_b128 v[28:31], v195 offset:4096
    s_waitcnt lgkmcnt(11)
    v_mfma_f32_32x32x16_bf16 v[112:127], v[44:47], v[16:19], v[112:127]
    ds_read_b128 v[16:19], v196 offset:0
    s_waitcnt lgkmcnt(11)
    v_mfma_f32_32x32x16_bf16 v[128:143], v[32:35], v[20:23], v[128:143]
    ds_read_b64_tr_b16 v[32:33], v192 offset:8192
    ds_read_b64_tr_b16 v[34:35], v192 offset:9216
    v_mfma_f32_32x32x16_bf16 v[144:159], v[36:39], v[20:23], v[144:159]
    ds_read_b64_tr_b16 v[36:37], v193 offset:8192
    v_mfma_f32_32x32x16_bf16 v[160:175], v[40:43], v[20:23], v[160:175]
    v_mfma_f32_32x32x16_bf16 v[176:191], v[44:47], v[20:23], v[176:191]
    s_waitcnt lgkmcnt(11)
    v_mfma_f32_32x32x16_bf16 v[64:79], v[48:51], v[24:27], v[64:79]
    ds_read_b64_tr_b16 v[38:39], v193 offset:9216
    ds_read_b64_tr_b16 v[40:41], v192 offset:24576
    s_waitcnt lgkmcnt(11)
    v_mfma_f32_32x32x16_bf16 v[80:95], v[52:55], v[24:27], v[80:95]
    ds_read_b64_tr_b16 v[42:43], v192 offset:25600
    ds_read_b64_tr_b16 v[44:45], v193 offset:24576
    s_waitcnt lgkmcnt(11)
    v_mfma_f32_32x32x16_bf16 v[96:111], v[56:59], v[24:27], v[96:111]
    ds_read_b64_tr_b16 v[46:47], v193 offset:25600
    ds_read_b128 v[20:23], v196 offset:4096
    s_waitcnt lgkmcnt(11)
    v_mfma_f32_32x32x16_bf16 v[112:127], v[60:63], v[24:27], v[112:127]
    ds_read_b128 v[24:27], v197 offset:0
    s_waitcnt lgkmcnt(11)
    v_mfma_f32_32x32x16_bf16 v[128:143], v[48:51], v[28:31], v[128:143]
    ds_read_b64_tr_b16 v[48:49], v192 offset:12288
    ds_read_b64_tr_b16 v[50:51], v192 offset:13312
    v_mfma_f32_32x32x16_bf16 v[144:159], v[52:55], v[28:31], v[144:159]
    ds_read_b64_tr_b16 v[52:53], v193 offset:12288
    v_mfma_f32_32x32x16_bf16 v[160:175], v[56:59], v[28:31], v[160:175]
    v_mfma_f32_32x32x16_bf16 v[176:191], v[60:63], v[28:31], v[176:191]
    s_waitcnt lgkmcnt(11)
    v_mfma_f32_32x32x16_bf16 v[64:79], v[32:35], v[16:19], v[64:79]
    ds_read_b64_tr_b16 v[54:55], v193 offset:13312
    ds_read_b64_tr_b16 v[56:57], v192 offset:28672
    s_waitcnt lgkmcnt(11)
    v_mfma_f32_32x32x16_bf16 v[80:95], v[36:39], v[16:19], v[80:95]
    ds_read_b64_tr_b16 v[58:59], v192 offset:29696
    ds_read_b64_tr_b16 v[60:61], v193 offset:28672
    s_waitcnt lgkmcnt(11)
    v_mfma_f32_32x32x16_bf16 v[96:111], v[40:43], v[16:19], v[96:111]
    ds_read_b64_tr_b16 v[62:63], v193 offset:29696
    ds_read_b128 v[28:31], v197 offset:4096
    s_waitcnt lgkmcnt(11)
    v_mfma_f32_32x32x16_bf16 v[112:127], v[44:47], v[16:19], v[112:127]
    s_waitcnt lgkmcnt(10)
    v_mfma_f32_32x32x16_bf16 v[128:143], v[32:35], v[20:23], v[128:143]
    v_mfma_f32_32x32x16_bf16 v[144:159], v[36:39], v[20:23], v[144:159]
    v_mfma_f32_32x32x16_bf16 v[160:175], v[40:43], v[20:23], v[160:175]
    v_mfma_f32_32x32x16_bf16 v[176:191], v[44:47], v[20:23], v[176:191]
    s_waitcnt lgkmcnt(7)
    v_mfma_f32_32x32x16_bf16 v[64:79], v[48:51], v[24:27], v[64:79]
    s_waitcnt lgkmcnt(0)
    s_barrier
    ds_read_b128 v[16:19], v200 offset:0
    ds_read_b64_tr_b16 v[32:33], v198 offset:0
    v_mfma_f32_32x32x16_bf16 v[80:95], v[52:55], v[24:27], v[80:95]
    ds_read_b64_tr_b16 v[34:35], v198 offset:1024
    ds_read_b64_tr_b16 v[36:37], v199 offset:0
    v_mfma_f32_32x32x16_bf16 v[96:111], v[56:59], v[24:27], v[96:111]
    ds_read_b64_tr_b16 v[38:39], v199 offset:1024
    ds_read_b64_tr_b16 v[40:41], v198 offset:16384
    v_mfma_f32_32x32x16_bf16 v[112:127], v[60:63], v[24:27], v[112:127]
    ds_read_b64_tr_b16 v[42:43], v198 offset:17408
    ds_read_b64_tr_b16 v[44:45], v199 offset:16384
    v_mfma_f32_32x32x16_bf16 v[128:143], v[48:51], v[28:31], v[128:143]
    ds_read_b64_tr_b16 v[46:47], v199 offset:17408
    ds_read_b128 v[20:23], v200 offset:4096
    v_mfma_f32_32x32x16_bf16 v[144:159], v[52:55], v[28:31], v[144:159]
    ds_read_b128 v[24:27], v201 offset:0
    ds_read_b64_tr_b16 v[48:49], v198 offset:4096
    v_mfma_f32_32x32x16_bf16 v[160:175], v[56:59], v[28:31], v[160:175]
    ds_read_b64_tr_b16 v[50:51], v198 offset:5120
    ds_read_b64_tr_b16 v[52:53], v199 offset:4096
    v_mfma_f32_32x32x16_bf16 v[176:191], v[60:63], v[28:31], v[176:191]
    s_waitcnt lgkmcnt(11)
    v_mfma_f32_32x32x16_bf16 v[64:79], v[32:35], v[16:19], v[64:79]
    ds_read_b64_tr_b16 v[54:55], v199 offset:5120
    ds_read_b64_tr_b16 v[56:57], v198 offset:20480
    s_waitcnt lgkmcnt(11)
    v_mfma_f32_32x32x16_bf16 v[80:95], v[36:39], v[16:19], v[80:95]
    ds_read_b64_tr_b16 v[58:59], v198 offset:21504
    ds_read_b64_tr_b16 v[60:61], v199 offset:20480
    s_waitcnt lgkmcnt(11)
    v_mfma_f32_32x32x16_bf16 v[96:111], v[40:43], v[16:19], v[96:111]
    ds_read_b64_tr_b16 v[62:63], v199 offset:21504
    ds_read_b128 v[28:31], v201 offset:4096
    s_waitcnt lgkmcnt(11)
    v_mfma_f32_32x32x16_bf16 v[112:127], v[44:47], v[16:19], v[112:127]
    ds_read_b128 v[16:19], v202 offset:0
    s_waitcnt lgkmcnt(11)
    v_mfma_f32_32x32x16_bf16 v[128:143], v[32:35], v[20:23], v[128:143]
    ds_read_b64_tr_b16 v[32:33], v198 offset:8192
    ds_read_b64_tr_b16 v[34:35], v198 offset:9216
    v_mfma_f32_32x32x16_bf16 v[144:159], v[36:39], v[20:23], v[144:159]
    ds_read_b64_tr_b16 v[36:37], v199 offset:8192
    v_mfma_f32_32x32x16_bf16 v[160:175], v[40:43], v[20:23], v[160:175]
    v_mfma_f32_32x32x16_bf16 v[176:191], v[44:47], v[20:23], v[176:191]
    s_waitcnt lgkmcnt(11)
    v_mfma_f32_32x32x16_bf16 v[64:79], v[48:51], v[24:27], v[64:79]
    ds_read_b64_tr_b16 v[38:39], v199 offset:9216
    ds_read_b64_tr_b16 v[40:41], v198 offset:24576
    s_waitcnt lgkmcnt(11)
    v_mfma_f32_32x32x16_bf16 v[80:95], v[52:55], v[24:27], v[80:95]
    ds_read_b64_tr_b16 v[42:43], v198 offset:25600
    ds_read_b64_tr_b16 v[44:45], v199 offset:24576
    s_waitcnt lgkmcnt(11)
    v_mfma_f32_32x32x16_bf16 v[96:111], v[56:59], v[24:27], v[96:111]
    ds_read_b64_tr_b16 v[46:47], v199 offset:25600
    ds_read_b128 v[20:23], v202 offset:4096
    s_waitcnt lgkmcnt(11)
    v_mfma_f32_32x32x16_bf16 v[112:127], v[60:63], v[24:27], v[112:127]
    ds_read_b128 v[24:27], v203 offset:0
    s_waitcnt lgkmcnt(11)
    v_mfma_f32_32x32x16_bf16 v[128:143], v[48:51], v[28:31], v[128:143]
    ds_read_b64_tr_b16 v[48:49], v198 offset:12288
    ds_read_b64_tr_b16 v[50:51], v198 offset:13312
    v_mfma_f32_32x32x16_bf16 v[144:159], v[52:55], v[28:31], v[144:159]
    ds_read_b64_tr_b16 v[52:53], v199 offset:12288
    v_mfma_f32_32x32x16_bf16 v[160:175], v[56:59], v[28:31], v[160:175]
    v_mfma_f32_32x32x16_bf16 v[176:191], v[60:63], v[28:31], v[176:191]
    s_waitcnt lgkmcnt(11)
    v_mfma_f32_32x32x16_bf16 v[64:79], v[32:35], v[16:19], v[64:79]
    ds_read_b64_tr_b16 v[54:55], v199 offset:13312
    ds_read_b64_tr_b16 v[56:57], v198 offset:28672
    s_waitcnt lgkmcnt(11)
    v_mfma_f32_32x32x16_bf16 v[80:95], v[36:39], v[16:19], v[80:95]
    ds_read_b64_tr_b16 v[58:59], v198 offset:29696
    ds_read_b64_tr_b16 v[60:61], v199 offset:28672
    s_waitcnt lgkmcnt(11)
    v_mfma_f32_32x32x16_bf16 v[96:111], v[40:43], v[16:19], v[96:111]
    ds_read_b64_tr_b16 v[62:63], v199 offset:29696
    ds_read_b128 v[28:31], v203 offset:4096
    s_waitcnt lgkmcnt(11)
    v_mfma_f32_32x32x16_bf16 v[112:127], v[44:47], v[16:19], v[112:127]
    s_waitcnt lgkmcnt(10)
    v_mfma_f32_32x32x16_bf16 v[128:143], v[32:35], v[20:23], v[128:143]
    v_mfma_f32_32x32x16_bf16 v[144:159], v[36:39], v[20:23], v[144:159]
    v_mfma_f32_32x32x16_bf16 v[160:175], v[40:43], v[20:23], v[160:175]
    v_mfma_f32_32x32x16_bf16 v[176:191], v[44:47], v[20:23], v[176:191]
    s_waitcnt lgkmcnt(7)
    v_mfma_f32_32x32x16_bf16 v[64:79], v[48:51], v[24:27], v[64:79]
    s_waitcnt lgkmcnt(0)
    s_barrier
    ds_read_b128 v[16:19], v206 offset:0
    ds_read_b64_tr_b16 v[32:33], v204 offset:0
    v_mfma_f32_32x32x16_bf16 v[80:95], v[52:55], v[24:27], v[80:95]
    ds_read_b64_tr_b16 v[34:35], v204 offset:1024
    ds_read_b64_tr_b16 v[36:37], v205 offset:0
    v_mfma_f32_32x32x16_bf16 v[96:111], v[56:59], v[24:27], v[96:111]
    ds_read_b64_tr_b16 v[38:39], v205 offset:1024
    ds_read_b64_tr_b16 v[40:41], v204 offset:16384
    v_mfma_f32_32x32x16_bf16 v[112:127], v[60:63], v[24:27], v[112:127]
    ds_read_b64_tr_b16 v[42:43], v204 offset:17408
    ds_read_b64_tr_b16 v[44:45], v205 offset:16384
    v_mfma_f32_32x32x16_bf16 v[128:143], v[48:51], v[28:31], v[128:143]
    ds_read_b64_tr_b16 v[46:47], v205 offset:17408
    ds_read_b128 v[20:23], v206 offset:4096
    v_mfma_f32_32x32x16_bf16 v[144:159], v[52:55], v[28:31], v[144:159]
    ds_read_b128 v[24:27], v207 offset:0
    ds_read_b64_tr_b16 v[48:49], v204 offset:4096
    v_mfma_f32_32x32x16_bf16 v[160:175], v[56:59], v[28:31], v[160:175]
    ds_read_b64_tr_b16 v[50:51], v204 offset:5120
    ds_read_b64_tr_b16 v[52:53], v205 offset:4096
    v_mfma_f32_32x32x16_bf16 v[176:191], v[60:63], v[28:31], v[176:191]
    s_waitcnt lgkmcnt(11)
    v_mfma_f32_32x32x16_bf16 v[64:79], v[32:35], v[16:19], v[64:79]
    ds_read_b64_tr_b16 v[54:55], v205 offset:5120
    ds_read_b64_tr_b16 v[56:57], v204 offset:20480
    s_waitcnt lgkmcnt(11)
    v_mfma_f32_32x32x16_bf16 v[80:95], v[36:39], v[16:19], v[80:95]
    ds_read_b64_tr_b16 v[58:59], v204 offset:21504
    ds_read_b64_tr_b16 v[60:61], v205 offset:20480
    s_waitcnt lgkmcnt(11)
    v_mfma_f32_32x32x16_bf16 v[96:111], v[40:43], v[16:19], v[96:111]
    ds_read_b64_tr_b16 v[62:63], v205 offset:21504
    ds_read_b128 v[28:31], v207 offset:4096
    s_waitcnt lgkmcnt(11)
    v_mfma_f32_32x32x16_bf16 v[112:127], v[44:47], v[16:19], v[112:127]
    ds_read_b128 v[16:19], v208 offset:0
    s_waitcnt lgkmcnt(11)
    v_mfma_f32_32x32x16_bf16 v[128:143], v[32:35], v[20:23], v[128:143]
    ds_read_b64_tr_b16 v[32:33], v204 offset:8192
    ds_read_b64_tr_b16 v[34:35], v204 offset:9216
    v_mfma_f32_32x32x16_bf16 v[144:159], v[36:39], v[20:23], v[144:159]
    ds_read_b64_tr_b16 v[36:37], v205 offset:8192
    v_mfma_f32_32x32x16_bf16 v[160:175], v[40:43], v[20:23], v[160:175]
    v_mfma_f32_32x32x16_bf16 v[176:191], v[44:47], v[20:23], v[176:191]
    s_waitcnt lgkmcnt(11)
    v_mfma_f32_32x32x16_bf16 v[64:79], v[48:51], v[24:27], v[64:79]
    ds_read_b64_tr_b16 v[38:39], v205 offset:9216
    ds_read_b64_tr_b16 v[40:41], v204 offset:24576
    s_waitcnt lgkmcnt(11)
    v_mfma_f32_32x32x16_bf16 v[80:95], v[52:55], v[24:27], v[80:95]
    ds_read_b64_tr_b16 v[42:43], v204 offset:25600
    ds_read_b64_tr_b16 v[44:45], v205 offset:24576
    s_waitcnt lgkmcnt(11)
    v_mfma_f32_32x32x16_bf16 v[96:111], v[56:59], v[24:27], v[96:111]
    ds_read_b64_tr_b16 v[46:47], v205 offset:25600
    ds_read_b128 v[20:23], v208 offset:4096
    s_waitcnt lgkmcnt(11)
    v_mfma_f32_32x32x16_bf16 v[112:127], v[60:63], v[24:27], v[112:127]
    ds_read_b128 v[24:27], v209 offset:0
    s_waitcnt lgkmcnt(11)
    v_mfma_f32_32x32x16_bf16 v[128:143], v[48:51], v[28:31], v[128:143]
    ds_read_b64_tr_b16 v[48:49], v204 offset:12288
    ds_read_b64_tr_b16 v[50:51], v204 offset:13312
    v_mfma_f32_32x32x16_bf16 v[144:159], v[52:55], v[28:31], v[144:159]
    ds_read_b64_tr_b16 v[52:53], v205 offset:12288
    v_mfma_f32_32x32x16_bf16 v[160:175], v[56:59], v[28:31], v[160:175]
    v_mfma_f32_32x32x16_bf16 v[176:191], v[60:63], v[28:31], v[176:191]
    s_waitcnt lgkmcnt(11)
    v_mfma_f32_32x32x16_bf16 v[64:79], v[32:35], v[16:19], v[64:79]
    ds_read_b64_tr_b16 v[54:55], v205 offset:13312
    ds_read_b64_tr_b16 v[56:57], v204 offset:28672
    s_waitcnt lgkmcnt(11)
    v_mfma_f32_32x32x16_bf16 v[80:95], v[36:39], v[16:19], v[80:95]
    ds_read_b64_tr_b16 v[58:59], v204 offset:29696
    ds_read_b64_tr_b16 v[60:61], v205 offset:28672
    s_waitcnt lgkmcnt(11)
    v_mfma_f32_32x32x16_bf16 v[96:111], v[40:43], v[16:19], v[96:111]
    ds_read_b64_tr_b16 v[62:63], v205 offset:29696
    ds_read_b128 v[28:31], v209 offset:4096
    s_waitcnt lgkmcnt(11)
    v_mfma_f32_32x32x16_bf16 v[112:127], v[44:47], v[16:19], v[112:127]
    s_waitcnt lgkmcnt(10)
    v_mfma_f32_32x32x16_bf16 v[128:143], v[32:35], v[20:23], v[128:143]
    v_mfma_f32_32x32x16_bf16 v[144:159], v[36:39], v[20:23], v[144:159]
    v_mfma_f32_32x32x16_bf16 v[160:175], v[40:43], v[20:23], v[160:175]
    v_mfma_f32_32x32x16_bf16 v[176:191], v[44:47], v[20:23], v[176:191]
    s_waitcnt lgkmcnt(7)
    v_mfma_f32_32x32x16_bf16 v[64:79], v[48:51], v[24:27], v[64:79]
    s_waitcnt lgkmcnt(0)
    s_barrier
    ds_read_b128 v[16:19], v194 offset:0
    ds_read_b64_tr_b16 v[32:33], v192 offset:0
    v_mfma_f32_32x32x16_bf16 v[80:95], v[52:55], v[24:27], v[80:95]
    ds_read_b64_tr_b16 v[34:35], v192 offset:1024
    ds_read_b64_tr_b16 v[36:37], v193 offset:0
    v_mfma_f32_32x32x16_bf16 v[96:111], v[56:59], v[24:27], v[96:111]
    ds_read_b64_tr_b16 v[38:39], v193 offset:1024
    ds_read_b64_tr_b16 v[40:41], v192 offset:16384
    v_mfma_f32_32x32x16_bf16 v[112:127], v[60:63], v[24:27], v[112:127]
    ds_read_b64_tr_b16 v[42:43], v192 offset:17408
    ds_read_b64_tr_b16 v[44:45], v193 offset:16384
    v_mfma_f32_32x32x16_bf16 v[128:143], v[48:51], v[28:31], v[128:143]
    ds_read_b64_tr_b16 v[46:47], v193 offset:17408
    ds_read_b128 v[20:23], v194 offset:4096
    v_mfma_f32_32x32x16_bf16 v[144:159], v[52:55], v[28:31], v[144:159]
    ds_read_b128 v[24:27], v195 offset:0
    ds_read_b64_tr_b16 v[48:49], v192 offset:4096
    v_mfma_f32_32x32x16_bf16 v[160:175], v[56:59], v[28:31], v[160:175]
    ds_read_b64_tr_b16 v[50:51], v192 offset:5120
    ds_read_b64_tr_b16 v[52:53], v193 offset:4096
    v_mfma_f32_32x32x16_bf16 v[176:191], v[60:63], v[28:31], v[176:191]
    s_waitcnt lgkmcnt(11)
    v_mfma_f32_32x32x16_bf16 v[64:79], v[32:35], v[16:19], v[64:79]
    ds_read_b64_tr_b16 v[54:55], v193 offset:5120
    ds_read_b64_tr_b16 v[56:57], v192 offset:20480
    s_waitcnt lgkmcnt(11)
    v_mfma_f32_32x32x16_bf16 v[80:95], v[36:39], v[16:19], v[80:95]
    ds_read_b64_tr_b16 v[58:59], v192 offset:21504
    ds_read_b64_tr_b16 v[60:61], v193 offset:20480
    s_waitcnt lgkmcnt(11)
    v_mfma_f32_32x32x16_bf16 v[96:111], v[40:43], v[16:19], v[96:111]
    ds_read_b64_tr_b16 v[62:63], v193 offset:21504
    ds_read_b128 v[28:31], v195 offset:4096
    s_waitcnt lgkmcnt(11)
    v_mfma_f32_32x32x16_bf16 v[112:127], v[44:47], v[16:19], v[112:127]
    ds_read_b128 v[16:19], v196 offset:0
    s_waitcnt lgkmcnt(11)
    v_mfma_f32_32x32x16_bf16 v[128:143], v[32:35], v[20:23], v[128:143]
    ds_read_b64_tr_b16 v[32:33], v192 offset:8192
    ds_read_b64_tr_b16 v[34:35], v192 offset:9216
    v_mfma_f32_32x32x16_bf16 v[144:159], v[36:39], v[20:23], v[144:159]
    ds_read_b64_tr_b16 v[36:37], v193 offset:8192
    v_mfma_f32_32x32x16_bf16 v[160:175], v[40:43], v[20:23], v[160:175]
    v_mfma_f32_32x32x16_bf16 v[176:191], v[44:47], v[20:23], v[176:191]
    s_waitcnt lgkmcnt(11)
    v_mfma_f32_32x32x16_bf16 v[64:79], v[48:51], v[24:27], v[64:79]
    ds_read_b64_tr_b16 v[38:39], v193 offset:9216
    ds_read_b64_tr_b16 v[40:41], v192 offset:24576
    s_waitcnt lgkmcnt(11)
    v_mfma_f32_32x32x16_bf16 v[80:95], v[52:55], v[24:27], v[80:95]
    ds_read_b64_tr_b16 v[42:43], v192 offset:25600
    ds_read_b64_tr_b16 v[44:45], v193 offset:24576
    s_waitcnt lgkmcnt(11)
    v_mfma_f32_32x32x16_bf16 v[96:111], v[56:59], v[24:27], v[96:111]
    ds_read_b64_tr_b16 v[46:47], v193 offset:25600
    ds_read_b128 v[20:23], v196 offset:4096
    s_waitcnt lgkmcnt(11)
    v_mfma_f32_32x32x16_bf16 v[112:127], v[60:63], v[24:27], v[112:127]
    ds_read_b128 v[24:27], v197 offset:0
    s_waitcnt lgkmcnt(11)
    v_mfma_f32_32x32x16_bf16 v[128:143], v[48:51], v[28:31], v[128:143]
    ds_read_b64_tr_b16 v[48:49], v192 offset:12288
    ds_read_b64_tr_b16 v[50:51], v192 offset:13312
    v_mfma_f32_32x32x16_bf16 v[144:159], v[52:55], v[28:31], v[144:159]
    ds_read_b64_tr_b16 v[52:53], v193 offset:12288
    v_mfma_f32_32x32x16_bf16 v[160:175], v[56:59], v[28:31], v[160:175]
    v_mfma_f32_32x32x16_bf16 v[176:191], v[60:63], v[28:31], v[176:191]
    s_waitcnt lgkmcnt(11)
    v_mfma_f32_32x32x16_bf16 v[64:79], v[32:35], v[16:19], v[64:79]
    ds_read_b64_tr_b16 v[54:55], v193 offset:13312
    ds_read_b64_tr_b16 v[56:57], v192 offset:28672
    s_waitcnt lgkmcnt(11)
    v_mfma_f32_32x32x16_bf16 v[80:95], v[36:39], v[16:19], v[80:95]
    ds_read_b64_tr_b16 v[58:59], v192 offset:29696
    ds_read_b64_tr_b16 v[60:61], v193 offset:28672
    s_waitcnt lgkmcnt(11)
    v_mfma_f32_32x32x16_bf16 v[96:111], v[40:43], v[16:19], v[96:111]
    ds_read_b64_tr_b16 v[62:63], v193 offset:29696
    ds_read_b128 v[28:31], v197 offset:4096
    s_waitcnt lgkmcnt(11)
    v_mfma_f32_32x32x16_bf16 v[112:127], v[44:47], v[16:19], v[112:127]
    s_waitcnt lgkmcnt(10)
    v_mfma_f32_32x32x16_bf16 v[128:143], v[32:35], v[20:23], v[128:143]
    v_mfma_f32_32x32x16_bf16 v[144:159], v[36:39], v[20:23], v[144:159]
    v_mfma_f32_32x32x16_bf16 v[160:175], v[40:43], v[20:23], v[160:175]
    v_mfma_f32_32x32x16_bf16 v[176:191], v[44:47], v[20:23], v[176:191]
    s_waitcnt lgkmcnt(7)
    v_mfma_f32_32x32x16_bf16 v[64:79], v[48:51], v[24:27], v[64:79]
    s_waitcnt lgkmcnt(0)
    s_barrier
    ds_read_b128 v[16:19], v200 offset:0
    ds_read_b64_tr_b16 v[32:33], v198 offset:0
    v_mfma_f32_32x32x16_bf16 v[80:95], v[52:55], v[24:27], v[80:95]
    ds_read_b64_tr_b16 v[34:35], v198 offset:1024
    ds_read_b64_tr_b16 v[36:37], v198 offset:16384
    v_mfma_f32_32x32x16_bf16 v[96:111], v[56:59], v[24:27], v[96:111]
    ds_read_b64_tr_b16 v[38:39], v198 offset:17408
    ds_read_b128 v[20:23], v201 offset:0
    v_mfma_f32_32x32x16_bf16 v[112:127], v[60:63], v[24:27], v[112:127]
    ds_read_b64_tr_b16 v[40:41], v198 offset:4096
    ds_read_b64_tr_b16 v[42:43], v198 offset:5120
    v_mfma_f32_32x32x16_bf16 v[128:143], v[48:51], v[28:31], v[128:143]
    ds_read_b64_tr_b16 v[44:45], v198 offset:20480
    ds_read_b64_tr_b16 v[46:47], v198 offset:21504
    v_mfma_f32_32x32x16_bf16 v[144:159], v[52:55], v[28:31], v[144:159]
    ds_read_b128 v[224:227], v11 offset:0
    ds_read_b32 v212, v9 offset:0
    v_mfma_f32_32x32x16_bf16 v[160:175], v[56:59], v[28:31], v[160:175]
    ds_read_b32 v213, v9 offset:0
    ds_read_b128 v[228:231], v11 offset:1024
    v_mfma_f32_32x32x16_bf16 v[176:191], v[60:63], v[28:31], v[176:191]
    s_waitcnt lgkmcnt(11)
    v_mfma_f32_32x32x16_bf16 v[64:79], v[32:35], v[16:19], v[64:79]
    ds_read_b32 v214, v9 offset:128
    ds_read_b32 v215, v9 offset:128
    s_waitcnt lgkmcnt(11)
    v_mfma_f32_32x32x16_bf16 v[96:111], v[36:39], v[16:19], v[96:111]
    ds_read_b128 v[24:27], v202 offset:0
    ds_read_b64_tr_b16 v[48:49], v198 offset:8192
    s_waitcnt lgkmcnt(10)
    v_mfma_f32_32x32x16_bf16 v[64:79], v[40:43], v[20:23], v[64:79]
    ds_read_b64_tr_b16 v[50:51], v198 offset:9216
    ds_read_b64_tr_b16 v[52:53], v198 offset:24576
    s_waitcnt lgkmcnt(10)
    v_mfma_f32_32x32x16_bf16 v[96:111], v[44:47], v[20:23], v[96:111]
    ds_read_b64_tr_b16 v[54:55], v198 offset:25600
    ds_read_b128 v[28:31], v203 offset:0
    s_waitcnt lgkmcnt(3)
    v_mfma_f32_32x32x16_bf16 v[64:79], v[48:51], v[24:27], v[64:79]
    ds_read_b64_tr_b16 v[56:57], v198 offset:12288
    ds_read_b64_tr_b16 v[58:59], v198 offset:13312
    s_waitcnt lgkmcnt(3)
    v_mfma_f32_32x32x16_bf16 v[96:111], v[52:55], v[24:27], v[96:111]
    ds_read_b64_tr_b16 v[60:61], v198 offset:28672
    ds_read_b64_tr_b16 v[62:63], v198 offset:29696
    s_waitcnt lgkmcnt(2)
    v_mfma_f32_32x32x16_bf16 v[64:79], v[56:59], v[28:31], v[64:79]
    ds_read_b128 v[216:219], v10 offset:0
    ds_read_b128 v[220:223], v10 offset:4096
    s_waitcnt lgkmcnt(2)
    v_mfma_f32_32x32x16_bf16 v[96:111], v[60:63], v[28:31], v[96:111]
    ds_read_b64_tr_b16 v[32:33], v199 offset:0
    ds_read_b64_tr_b16 v[34:35], v199 offset:1024
    s_waitcnt lgkmcnt(3)
    v_mfma_f32_32x32x16_bf16 v[64:79], v[216:219], v[224:227], v[64:79]
    ds_read_b64_tr_b16 v[36:37], v199 offset:16384
    ds_read_b64_tr_b16 v[38:39], v199 offset:17408
    s_waitcnt lgkmcnt(4)
    v_mfma_f32_32x32x16_bf16 v[96:111], v[220:223], v[224:227], v[96:111]
    ds_read_b64_tr_b16 v[40:41], v199 offset:4096
    ds_read_b64_tr_b16 v[42:43], v199 offset:5120
    s_waitcnt lgkmcnt(4)
    v_mfma_f32_32x32x16_bf16 v[80:95], v[32:35], v[16:19], v[80:95]
    ds_read_b64_tr_b16 v[44:45], v199 offset:20480
    ds_read_b64_tr_b16 v[46:47], v199 offset:21504
    s_waitcnt lgkmcnt(4)
    v_mfma_f32_32x32x16_bf16 v[112:127], v[36:39], v[16:19], v[112:127]
    ds_read_b64_tr_b16 v[48:49], v199 offset:8192
    ds_read_b64_tr_b16 v[50:51], v199 offset:9216
    v_mul_f32 v64, v64, v212
    v_mul_f32 v65, v65, v213
    v_mul_f32 v96, v96, v212
    v_mul_f32 v97, v97, v213
    v_cvt_pk_bf16_f32 v64, 0, v64
    v_cvt_pk_bf16_f32 v65, 0, v65
    s_waitcnt lgkmcnt(4)
    v_mfma_f32_32x32x16_bf16 v[80:95], v[40:43], v[20:23], v[80:95]
    ds_read_b64_tr_b16 v[52:53], v199 offset:24576
    ds_read_b64_tr_b16 v[54:55], v199 offset:25600
    v_cvt_pk_bf16_f32 v96, 0, v96
    v_cvt_pk_bf16_f32 v97, 0, v97
    v_mul_f32 v64, v64, v96
    v_mul_f32 v65, v65, v97
    v_cvt_pk_bf16_f32 v64, v64, v65
    v_mul_f32 v66, v66, v212
    s_waitcnt lgkmcnt(4)
    v_mfma_f32_32x32x16_bf16 v[112:127], v[44:47], v[20:23], v[112:127]
    ds_read_b64_tr_b16 v[56:57], v199 offset:12288
    ds_read_b64_tr_b16 v[58:59], v199 offset:13312
    v_mul_f32 v67, v67, v213
    v_mul_f32 v98, v98, v212
    v_mul_f32 v99, v99, v213
    v_cvt_pk_bf16_f32 v66, 0, v66
    v_cvt_pk_bf16_f32 v67, 0, v67
    v_cvt_pk_bf16_f32 v98, 0, v98
    s_waitcnt lgkmcnt(4)
    v_mfma_f32_32x32x16_bf16 v[80:95], v[48:51], v[24:27], v[80:95]
    ds_read_b64_tr_b16 v[60:61], v199 offset:28672
    ds_read_b64_tr_b16 v[62:63], v199 offset:29696
    v_cvt_pk_bf16_f32 v99, 0, v99
    v_mul_f32 v66, v66, v98
    v_mul_f32 v67, v67, v99
    v_cvt_pk_bf16_f32 v65, v66, v67
    v_mul_f32 v68, v68, v212
    v_mul_f32 v69, v69, v213
    s_waitcnt lgkmcnt(4)
    v_mfma_f32_32x32x16_bf16 v[112:127], v[52:55], v[24:27], v[112:127]
    ds_read_b128 v[216:219], v10 offset:1024
    ds_read_b128 v[220:223], v10 offset:5120
    v_mul_f32 v100, v100, v212
    v_mul_f32 v101, v101, v213
    v_cvt_pk_bf16_f32 v68, 0, v68
    v_cvt_pk_bf16_f32 v69, 0, v69
    v_cvt_pk_bf16_f32 v100, 0, v100
    v_cvt_pk_bf16_f32 v101, 0, v101
    s_waitcnt lgkmcnt(4)
    v_mfma_f32_32x32x16_bf16 v[80:95], v[56:59], v[28:31], v[80:95]
    ds_read_b128 v[16:19], v200 offset:4096
    ds_read_b64_tr_b16 v[32:33], v198 offset:0
    v_mul_f32 v68, v68, v100
    v_mul_f32 v69, v69, v101
    v_cvt_pk_bf16_f32 v66, v68, v69
    v_mul_f32 v70, v70, v212
    v_mul_f32 v71, v71, v213
    v_mul_f32 v102, v102, v212
    s_waitcnt lgkmcnt(4)
    v_mfma_f32_32x32x16_bf16 v[112:127], v[60:63], v[28:31], v[112:127]
    ds_read_b64_tr_b16 v[34:35], v198 offset:1024
    ds_read_b64_tr_b16 v[36:37], v198 offset:16384
    v_mul_f32 v103, v103, v213
    v_cvt_pk_bf16_f32 v70, 0, v70
    v_cvt_pk_bf16_f32 v71, 0, v71
    v_cvt_pk_bf16_f32 v102, 0, v102
    v_cvt_pk_bf16_f32 v103, 0, v103
    v_mul_f32 v70, v70, v102
    s_waitcnt lgkmcnt(5)
    v_mfma_f32_32x32x16_bf16 v[80:95], v[216:219], v[224:227], v[80:95]
    ds_read_b64_tr_b16 v[38:39], v198 offset:17408
    ds_read_b128 v[20:23], v201 offset:4096
    v_mul_f32 v71, v71, v103
    v_cvt_pk_bf16_f32 v67, v70, v71
    s_add_u32 s63, s67, 0
    buffer_store_dwordx4 v[64:67], v210, s[56:59], s63 offen sc1
    v_mul_f32 v72, v72, v212
    v_mul_f32 v73, v73, v213
    s_waitcnt lgkmcnt(6)
    v_mfma_f32_32x32x16_bf16 v[112:127], v[220:223], v[224:227], v[112:127]
    ds_read_b64_tr_b16 v[40:41], v198 offset:4096
    ds_read_b64_tr_b16 v[42:43], v198 offset:5120
    v_mul_f32 v104, v104, v212
    v_mul_f32 v105, v105, v213
    v_cvt_pk_bf16_f32 v72, 0, v72
    v_cvt_pk_bf16_f32 v73, 0, v73
    v_cvt_pk_bf16_f32 v104, 0, v104
    v_cvt_pk_bf16_f32 v105, 0, v105
    s_waitcnt lgkmcnt(5)
    v_mfma_f32_32x32x16_bf16 v[128:143], v[32:35], v[16:19], v[128:143]
    ds_read_b64_tr_b16 v[44:45], v198 offset:20480
    ds_read_b64_tr_b16 v[46:47], v198 offset:21504
    v_mul_f32 v72, v72, v104
    v_mul_f32 v73, v73, v105
    v_cvt_pk_bf16_f32 v68, v72, v73
    v_mul_f32 v74, v74, v212
    v_mul_f32 v75, v75, v213
    v_mul_f32 v106, v106, v212
    s_waitcnt lgkmcnt(5)
    v_mfma_f32_32x32x16_bf16 v[160:175], v[36:39], v[16:19], v[160:175]
    ds_read_b128 v[24:27], v202 offset:4096
    ds_read_b64_tr_b16 v[48:49], v198 offset:8192
    v_mul_f32 v107, v107, v213
    v_cvt_pk_bf16_f32 v74, 0, v74
    v_cvt_pk_bf16_f32 v75, 0, v75
    v_cvt_pk_bf16_f32 v106, 0, v106
    v_cvt_pk_bf16_f32 v107, 0, v107
    v_mul_f32 v74, v74, v106
    s_waitcnt lgkmcnt(4)
    v_mfma_f32_32x32x16_bf16 v[128:143], v[40:43], v[20:23], v[128:143]
    ds_read_b64_tr_b16 v[50:51], v198 offset:9216
    ds_read_b64_tr_b16 v[52:53], v198 offset:24576
    v_mul_f32 v75, v75, v107
    v_cvt_pk_bf16_f32 v69, v74, v75
    v_mul_f32 v76, v76, v212
    v_mul_f32 v77, v77, v213
    v_mul_f32 v108, v108, v212
    v_mul_f32 v109, v109, v213
    s_waitcnt lgkmcnt(4)
    v_mfma_f32_32x32x16_bf16 v[160:175], v[44:47], v[20:23], v[160:175]
    ds_read_b64_tr_b16 v[54:55], v198 offset:25600
    ds_read_b128 v[28:31], v203 offset:4096
    v_cvt_pk_bf16_f32 v76, 0, v76
    v_cvt_pk_bf16_f32 v77, 0, v77
    v_cvt_pk_bf16_f32 v108, 0, v108
    v_cvt_pk_bf16_f32 v109, 0, v109
    v_mul_f32 v76, v76, v108
    v_mul_f32 v77, v77, v109
    s_waitcnt lgkmcnt(3)
    v_mfma_f32_32x32x16_bf16 v[128:143], v[48:51], v[24:27], v[128:143]
    ds_read_b64_tr_b16 v[56:57], v198 offset:12288
    ds_read_b64_tr_b16 v[58:59], v198 offset:13312
    v_cvt_pk_bf16_f32 v70, v76, v77
    v_mul_f32 v78, v78, v212
    v_mul_f32 v79, v79, v213
    v_mul_f32 v110, v110, v212
    v_mul_f32 v111, v111, v213
    v_cvt_pk_bf16_f32 v78, 0, v78
    s_waitcnt lgkmcnt(3)
    v_mfma_f32_32x32x16_bf16 v[160:175], v[52:55], v[24:27], v[160:175]
    ds_read_b64_tr_b16 v[60:61], v198 offset:28672
    ds_read_b64_tr_b16 v[62:63], v198 offset:29696
    v_cvt_pk_bf16_f32 v79, 0, v79
    v_cvt_pk_bf16_f32 v110, 0, v110
    v_cvt_pk_bf16_f32 v111, 0, v111
    v_mul_f32 v78, v78, v110
    v_mul_f32 v79, v79, v111
    v_cvt_pk_bf16_f32 v71, v78, v79
    s_waitcnt lgkmcnt(2)
    v_mfma_f32_32x32x16_bf16 v[128:143], v[56:59], v[28:31], v[128:143]
    ds_read_b128 v[216:219], v10 offset:0
    ds_read_b128 v[220:223], v10 offset:4096
    s_add_u32 s63, s67, 1024
    buffer_store_dwordx4 v[68:71], v210, s[56:59], s63 offen sc1
    v_mul_f32 v80, v80, v212
    v_mul_f32 v81, v81, v213
    v_mul_f32 v112, v112, v212
    v_mul_f32 v113, v113, v213
    s_waitcnt lgkmcnt(2)
    v_mfma_f32_32x32x16_bf16 v[160:175], v[60:63], v[28:31], v[160:175]
    ds_read_b64_tr_b16 v[32:33], v199 offset:0
    ds_read_b64_tr_b16 v[34:35], v199 offset:1024
    v_cvt_pk_bf16_f32 v80, 0, v80
    v_cvt_pk_bf16_f32 v81, 0, v81
    v_cvt_pk_bf16_f32 v112, 0, v112
    v_cvt_pk_bf16_f32 v113, 0, v113
    v_mul_f32 v80, v80, v112
    v_mul_f32 v81, v81, v113
    s_waitcnt lgkmcnt(3)
    v_mfma_f32_32x32x16_bf16 v[128:143], v[216:219], v[228:231], v[128:143]
    ds_read_b64_tr_b16 v[36:37], v199 offset:16384
    ds_read_b64_tr_b16 v[38:39], v199 offset:17408
    v_cvt_pk_bf16_f32 v80, v80, v81
    v_mul_f32 v82, v82, v212
    v_mul_f32 v83, v83, v213
    v_mul_f32 v114, v114, v212
    v_mul_f32 v115, v115, v213
    v_cvt_pk_bf16_f32 v82, 0, v82
    s_waitcnt lgkmcnt(4)
    v_mfma_f32_32x32x16_bf16 v[160:175], v[220:223], v[228:231], v[160:175]
    ds_read_b64_tr_b16 v[40:41], v199 offset:4096
    ds_read_b64_tr_b16 v[42:43], v199 offset:5120
    v_cvt_pk_bf16_f32 v83, 0, v83
    v_cvt_pk_bf16_f32 v114, 0, v114
    v_cvt_pk_bf16_f32 v115, 0, v115
    v_mul_f32 v82, v82, v114
    v_mul_f32 v83, v83, v115
    v_cvt_pk_bf16_f32 v81, v82, v83
    s_waitcnt lgkmcnt(4)
    v_mfma_f32_32x32x16_bf16 v[144:159], v[32:35], v[16:19], v[144:159]
    ds_read_b64_tr_b16 v[44:45], v199 offset:20480
    ds_read_b64_tr_b16 v[46:47], v199 offset:21504
    v_mul_f32 v84, v84, v212
    v_mul_f32 v85, v85, v213
    v_mul_f32 v116, v116, v212
    v_mul_f32 v117, v117, v213
    v_cvt_pk_bf16_f32 v84, 0, v84
    v_cvt_pk_bf16_f32 v85, 0, v85
    s_waitcnt lgkmcnt(4)
    v_mfma_f32_32x32x16_bf16 v[176:191], v[36:39], v[16:19], v[176:191]
    ds_read_b64_tr_b16 v[48:49], v199 offset:8192
    ds_read_b64_tr_b16 v[50:51], v199 offset:9216
    v_cvt_pk_bf16_f32 v116, 0, v116
    v_cvt_pk_bf16_f32 v117, 0, v117
    v_mul_f32 v84, v84, v116
    v_mul_f32 v85, v85, v117
    v_cvt_pk_bf16_f32 v82, v84, v85
    v_mul_f32 v86, v86, v212
    s_waitcnt lgkmcnt(4)
    v_mfma_f32_32x32x16_bf16 v[144:159], v[40:43], v[20:23], v[144:159]
    ds_read_b64_tr_b16 v[52:53], v199 offset:24576
    ds_read_b64_tr_b16 v[54:55], v199 offset:25600
    v_mul_f32 v87, v87, v213
    v_mul_f32 v118, v118, v212
    v_mul_f32 v119, v119, v213
    v_cvt_pk_bf16_f32 v86, 0, v86
    v_cvt_pk_bf16_f32 v87, 0, v87
    v_cvt_pk_bf16_f32 v118, 0, v118
    s_waitcnt lgkmcnt(4)
    v_mfma_f32_32x32x16_bf16 v[176:191], v[44:47], v[20:23], v[176:191]
    ds_read_b64_tr_b16 v[56:57], v199 offset:12288
    ds_read_b64_tr_b16 v[58:59], v199 offset:13312
    v_cvt_pk_bf16_f32 v119, 0, v119
    v_mul_f32 v86, v86, v118
    v_mul_f32 v87, v87, v119
    v_cvt_pk_bf16_f32 v83, v86, v87
    s_add_u32 s63, s67, 2048
    buffer_store_dwordx4 v[80:83], v210, s[56:59], s63 offen sc1
    s_waitcnt lgkmcnt(4)
    v_mfma_f32_32x32x16_bf16 v[144:159], v[48:51], v[24:27], v[144:159]
    ds_read_b64_tr_b16 v[60:61], v199 offset:28672
    ds_read_b64_tr_b16 v[62:63], v199 offset:29696
    v_mul_f32 v88, v88, v212
    v_mul_f32 v89, v89, v213
    v_mul_f32 v120, v120, v212
    v_mul_f32 v121, v121, v213
    v_cvt_pk_bf16_f32 v88, 0, v88
    v_cvt_pk_bf16_f32 v89, 0, v89
    s_waitcnt lgkmcnt(4)
    v_mfma_f32_32x32x16_bf16 v[176:191], v[52:55], v[24:27], v[176:191]
    ds_read_b128 v[216:219], v10 offset:1024
    ds_read_b128 v[220:223], v10 offset:5120
    v_cvt_pk_bf16_f32 v120, 0, v120
    v_cvt_pk_bf16_f32 v121, 0, v121
    v_mul_f32 v88, v88, v120
    v_mul_f32 v89, v89, v121
    v_cvt_pk_bf16_f32 v84, v88, v89
    v_mul_f32 v90, v90, v212
    s_waitcnt lgkmcnt(4)
    v_mfma_f32_32x32x16_bf16 v[144:159], v[56:59], v[28:31], v[144:159]
    v_mul_f32 v91, v91, v213
    v_mul_f32 v122, v122, v212
    v_mul_f32 v123, v123, v213
    v_cvt_pk_bf16_f32 v90, 0, v90
    v_cvt_pk_bf16_f32 v91, 0, v91
    v_cvt_pk_bf16_f32 v122, 0, v122
    s_waitcnt lgkmcnt(2)
    v_mfma_f32_32x32x16_bf16 v[176:191], v[60:63], v[28:31], v[176:191]
    v_cvt_pk_bf16_f32 v123, 0, v123
    v_mul_f32 v90, v90, v122
    v_mul_f32 v91, v91, v123
    v_cvt_pk_bf16_f32 v85, v90, v91
    v_mul_f32 v92, v92, v212
    v_mul_f32 v93, v93, v213
    s_waitcnt lgkmcnt(1)
    v_mfma_f32_32x32x16_bf16 v[144:159], v[216:219], v[228:231], v[144:159]
    v_mul_f32 v124, v124, v212
    v_mul_f32 v125, v125, v213
    v_cvt_pk_bf16_f32 v92, 0, v92
    v_cvt_pk_bf16_f32 v93, 0, v93
    v_cvt_pk_bf16_f32 v124, 0, v124
    v_cvt_pk_bf16_f32 v125, 0, v125
    s_waitcnt lgkmcnt(0)
    v_mfma_f32_32x32x16_bf16 v[176:191], v[220:223], v[228:231], v[176:191]
    v_mul_f32 v92, v92, v124
    v_mul_f32 v93, v93, v125
    v_cvt_pk_bf16_f32 v86, v92, v93
    v_mul_f32 v94, v94, v212
    v_mul_f32 v95, v95, v213
    v_mul_f32 v126, v126, v212
    v_mul_f32 v127, v127, v213
    v_cvt_pk_bf16_f32 v94, 0, v94
    v_cvt_pk_bf16_f32 v95, 0, v95
    v_cvt_pk_bf16_f32 v126, 0, v126
    v_cvt_pk_bf16_f32 v127, 0, v127
    v_mul_f32 v94, v94, v126
    v_mul_f32 v95, v95, v127
    v_cvt_pk_bf16_f32 v87, v94, v95
    s_add_u32 s63, s67, 3072
    buffer_store_dwordx4 v[84:87], v210, s[56:59], s63 offen sc1
    s_nop 15
    s_nop 3
    v_mul_f32 v128, v128, v214
    v_mul_f32 v129, v129, v215
    v_mul_f32 v160, v160, v214
    v_mul_f32 v161, v161, v215
    v_cvt_pk_bf16_f32 v128, 0, v128
    v_cvt_pk_bf16_f32 v129, 0, v129
    v_cvt_pk_bf16_f32 v160, 0, v160
    v_cvt_pk_bf16_f32 v161, 0, v161
    v_mul_f32 v128, v128, v160
    v_mul_f32 v129, v129, v161
    v_cvt_pk_bf16_f32 v128, v128, v129
    v_mul_f32 v130, v130, v214
    v_mul_f32 v131, v131, v215
    v_mul_f32 v162, v162, v214
    v_mul_f32 v163, v163, v215
    v_cvt_pk_bf16_f32 v130, 0, v130
    v_cvt_pk_bf16_f32 v131, 0, v131
    v_cvt_pk_bf16_f32 v162, 0, v162
    v_cvt_pk_bf16_f32 v163, 0, v163
    v_mul_f32 v130, v130, v162
    v_mul_f32 v131, v131, v163
    v_cvt_pk_bf16_f32 v129, v130, v131
    v_mul_f32 v132, v132, v214
    v_mul_f32 v133, v133, v215
    v_mul_f32 v164, v164, v214
    v_mul_f32 v165, v165, v215
    v_cvt_pk_bf16_f32 v132, 0, v132
    v_cvt_pk_bf16_f32 v133, 0, v133
    v_cvt_pk_bf16_f32 v164, 0, v164
    v_cvt_pk_bf16_f32 v165, 0, v165
    v_mul_f32 v132, v132, v164
    v_mul_f32 v133, v133, v165
    v_cvt_pk_bf16_f32 v130, v132, v133
    v_mul_f32 v134, v134, v214
    v_mul_f32 v135, v135, v215
    v_mul_f32 v166, v166, v214
    v_mul_f32 v167, v167, v215
    v_cvt_pk_bf16_f32 v134, 0, v134
    v_cvt_pk_bf16_f32 v135, 0, v135
    v_cvt_pk_bf16_f32 v166, 0, v166
    v_cvt_pk_bf16_f32 v167, 0, v167
    v_mul_f32 v134, v134, v166
    v_mul_f32 v135, v135, v167
    v_cvt_pk_bf16_f32 v131, v134, v135
    s_add_u32 s63, s67, 90112
    buffer_store_dwordx4 v[128:131], v210, s[56:59], s63 offen sc1
    v_mul_f32 v136, v136, v214
    v_mul_f32 v137, v137, v215
    v_mul_f32 v168, v168, v214
    v_mul_f32 v169, v169, v215
    v_cvt_pk_bf16_f32 v136, 0, v136
    v_cvt_pk_bf16_f32 v137, 0, v137
    v_cvt_pk_bf16_f32 v168, 0, v168
    v_cvt_pk_bf16_f32 v169, 0, v169
    v_mul_f32 v136, v136, v168
    v_mul_f32 v137, v137, v169
    v_cvt_pk_bf16_f32 v132, v136, v137
    v_mul_f32 v138, v138, v214
    v_mul_f32 v139, v139, v215
    v_mul_f32 v170, v170, v214
    v_mul_f32 v171, v171, v215
    v_cvt_pk_bf16_f32 v138, 0, v138
    v_cvt_pk_bf16_f32 v139, 0, v139
    v_cvt_pk_bf16_f32 v170, 0, v170
    v_cvt_pk_bf16_f32 v171, 0, v171
    v_mul_f32 v138, v138, v170
    v_mul_f32 v139, v139, v171
    v_cvt_pk_bf16_f32 v133, v138, v139
    v_mul_f32 v140, v140, v214
    v_mul_f32 v141, v141, v215
    v_mul_f32 v172, v172, v214
    v_mul_f32 v173, v173, v215
    v_cvt_pk_bf16_f32 v140, 0, v140
    v_cvt_pk_bf16_f32 v141, 0, v141
    v_cvt_pk_bf16_f32 v172, 0, v172
    v_cvt_pk_bf16_f32 v173, 0, v173
    v_mul_f32 v140, v140, v172
    v_mul_f32 v141, v141, v173
    v_cvt_pk_bf16_f32 v134, v140, v141
    v_mul_f32 v142, v142, v214
    v_mul_f32 v143, v143, v215
    v_mul_f32 v174, v174, v214
    v_mul_f32 v175, v175, v215
    v_cvt_pk_bf16_f32 v142, 0, v142
    v_cvt_pk_bf16_f32 v143, 0, v143
    v_cvt_pk_bf16_f32 v174, 0, v174
    v_cvt_pk_bf16_f32 v175, 0, v175
    v_mul_f32 v142, v142, v174
    v_mul_f32 v143, v143, v175
    v_cvt_pk_bf16_f32 v135, v142, v143
    s_add_u32 s63, s67, 91136
    buffer_store_dwordx4 v[132:135], v210, s[56:59], s63 offen sc1
    s_nop 15
    s_nop 3
    v_pk_mul_f32 v[144:145], v[144:145], v[214:215]
    v_pk_mul_f32 v[176:177], v[176:177], v[214:215]
    v_cvt_pk_bf16_f32 v144, 0, v144
    v_cvt_pk_bf16_f32 v145, 0, v145
    v_cvt_pk_bf16_f32 v176, 0, v176
    v_cvt_pk_bf16_f32 v177, 0, v177
    v_pk_mul_f32 v[144:145], v[144:145], v[176:177]
    v_cvt_pk_bf16_f32 v144, v144, v145
    v_pk_mul_f32 v[146:147], v[146:147], v[214:215]
    v_pk_mul_f32 v[178:179], v[178:179], v[214:215]
    v_cvt_pk_bf16_f32 v146, 0, v146
    v_cvt_pk_bf16_f32 v147, 0, v147
    v_cvt_pk_bf16_f32 v178, 0, v178
    v_cvt_pk_bf16_f32 v179, 0, v179
    v_pk_mul_f32 v[146:147], v[146:147], v[178:179]
    v_cvt_pk_bf16_f32 v145, v146, v147
    v_pk_mul_f32 v[148:149], v[148:149], v[214:215]
    v_pk_mul_f32 v[180:181], v[180:181], v[214:215]
    v_cvt_pk_bf16_f32 v148, 0, v148
    v_cvt_pk_bf16_f32 v149, 0, v149
    v_cvt_pk_bf16_f32 v180, 0, v180
    v_cvt_pk_bf16_f32 v181, 0, v181
    v_pk_mul_f32 v[148:149], v[148:149], v[180:181]
    v_cvt_pk_bf16_f32 v146, v148, v149
    v_pk_mul_f32 v[150:151], v[150:151], v[214:215]
    v_pk_mul_f32 v[182:183], v[182:183], v[214:215]
    v_cvt_pk_bf16_f32 v150, 0, v150
    v_cvt_pk_bf16_f32 v151, 0, v151
    v_cvt_pk_bf16_f32 v182, 0, v182
    v_cvt_pk_bf16_f32 v183, 0, v183
    v_pk_mul_f32 v[150:151], v[150:151], v[182:183]
    v_cvt_pk_bf16_f32 v147, v150, v151
    s_add_u32 s63, s67, 92160
    buffer_store_dwordx4 v[144:147], v210, s[56:59], s63 offen sc1
    v_pk_mul_f32 v[152:153], v[152:153], v[214:215]
    v_pk_mul_f32 v[184:185], v[184:185], v[214:215]
    v_cvt_pk_bf16_f32 v152, 0, v152
    v_cvt_pk_bf16_f32 v153, 0, v153
    v_cvt_pk_bf16_f32 v184, 0, v184
    v_cvt_pk_bf16_f32 v185, 0, v185
    v_pk_mul_f32 v[152:153], v[152:153], v[184:185]
    v_cvt_pk_bf16_f32 v148, v152, v153
    v_pk_mul_f32 v[154:155], v[154:155], v[214:215]
    v_pk_mul_f32 v[186:187], v[186:187], v[214:215]
    v_cvt_pk_bf16_f32 v154, 0, v154
    v_cvt_pk_bf16_f32 v155, 0, v155
    v_cvt_pk_bf16_f32 v186, 0, v186
    v_cvt_pk_bf16_f32 v187, 0, v187
    v_pk_mul_f32 v[154:155], v[154:155], v[186:187]
    v_cvt_pk_bf16_f32 v149, v154, v155
    v_pk_mul_f32 v[156:157], v[156:157], v[214:215]
    v_pk_mul_f32 v[188:189], v[188:189], v[214:215]
    v_cvt_pk_bf16_f32 v156, 0, v156
    v_cvt_pk_bf16_f32 v157, 0, v157
    v_cvt_pk_bf16_f32 v188, 0, v188
    v_cvt_pk_bf16_f32 v189, 0, v189
    v_pk_mul_f32 v[156:157], v[156:157], v[188:189]
    v_cvt_pk_bf16_f32 v150, v156, v157
    v_pk_mul_f32 v[158:159], v[158:159], v[214:215]
    v_pk_mul_f32 v[190:191], v[190:191], v[214:215]
    v_cvt_pk_bf16_f32 v158, 0, v158
    v_cvt_pk_bf16_f32 v159, 0, v159
    v_cvt_pk_bf16_f32 v190, 0, v190
    v_cvt_pk_bf16_f32 v191, 0, v191
    v_pk_mul_f32 v[158:159], v[158:159], v[190:191]
    v_cvt_pk_bf16_f32 v151, v158, v159
    s_add_u32 s63, s67, 93184
    buffer_store_dwordx4 v[148:151], v210, s[56:59], s63 offen sc1
    s_mov_b32 s82, 1
    s_mul_i32 s63, s65, 22528
    s_cmp_eq_u32 s66, 0
    s_cselect_b32 s64, 98304, 0
    s_add_u32 s63, s63, s64
    v_add_u32 v2, s63, v210
    s_mov_b32 s63, 15
    v_mov_b32 v14, 163328
    s_mov_b32 s80, 0
lw4:
    ds_read_b32 v15, v14 offset:8
    s_waitcnt lgkmcnt(0)
    v_readfirstlane_b32 s81, v15
    s_add_u32 s80, s80, 1
    s_nop 2
    s_and_b32 s81, s81, s63
    s_cmp_eq_u32 s81, s63
    s_cbranch_scc1 lwd4
    s_sleep 1
    s_cmp_lt_u32 s80, 0x1000000
    s_cbranch_scc1 lw4
lwd4:
    ds_read_b128 v[168:171], v2 offset:0
    ds_read_b128 v[172:175], v2 offset:1024
    ds_read_b128 v[176:179], v2 offset:2048
    ds_read_b128 v[180:183], v2 offset:3072
    ds_read_b128 v[184:187], v2 offset:4096
    ds_read_b128 v[188:191], v2 offset:5120
    ds_read_b128 v[192:195], v2 offset:6144
    ds_read_b128 v[196:199], v2 offset:7168
    ds_read_b128 v[200:203], v2 offset:8192
    ds_read_b128 v[204:207], v2 offset:9216
    ds_read_b128 v[208:211], v2 offset:10240
    ds_read_b128 v[212:215], v2 offset:11264
    ds_read_b128 v[216:219], v2 offset:12288
    ds_read_b128 v[220:223], v2 offset:13312
    ds_read_b128 v[224:227], v2 offset:14336
    ds_read_b128 v[228:231], v2 offset:15360
    ds_read_b128 v[232:235], v2 offset:16384
    ds_read_b128 v[236:239], v2 offset:17408
    ds_read_b128 v[240:243], v2 offset:18432
    ds_read_b128 v[244:247], v2 offset:19456
    ds_read_b128 v[248:251], v2 offset:20480
    ds_read_b128 v[252:255], v2 offset:21504
    v_mov_b32 v15, 1
    s_waitcnt lgkmcnt(0)
    s_mov_b64 exec, 1
    ds_add_u32 v14, v15
    s_mov_b64 exec, -1
    s_mov_b32 s43, -1
    s_branch g2_unit
k1_help:
    s_sub_u32 s65, s62, 4
    v_lshrrev_b32 v2, 2, v1
    v_mul_u32_u24 v2, 2752, v2
    v_and_b32 v3, 3, v1
    v_lshl_add_u32 v8, v3, 4, v2
    s_and_b32 s63, s60, 7
    s_mul_i32 s63, s63, 176128
    s_lshl_b32 s64, s61, 8
    s_add_u32 s63, s63, s64
    s_lshl_b32 s3, s65, 6
    s_add_u32 s3, s3, s63
    v_lshrrev_b32 v2, 3, v1
    v_and_b32 v3, 7, v1
    v_lshlrev_b32 v4, 4, v3
    v_lshl_add_u32 v9, v2, 10, v4
    s_lshl_b32 s67, s60, 17
    s_lshl_b32 s63, s65, 15
    s_add_u32 s67, s67, s63
    s_and_b32 s4, s61, 7
    s_lshl_b32 s4, s4, 7
    s_add_u32 s4, s4, s67
    v_lshrrev_b32 v4, 4, v1
    v_xor_b32 v3, v3, v4
    v_lshlrev_b32 v3, 4, v3
    v_lshl_add_u32 v10, v2, 10, v3
    v_xor_b32 v11, 64, v10
    v_and_b32 v5, 15, v1
    v_lshlrev_b32 v6, 2, v4
    v_xor_b32 v5, v5, v6
    v_lshlrev_b32 v5, 4, v5
    v_mul_u32_u24 v6, 2752, v4
    v_add_u32 v12, v5, v6
    s_mul_i32 s66, s65, 44032
    s_add_u32 s66, s66, s64
    s_lshl_b32 s68, s65, 12
    s_waitcnt lgkmcnt(0)
    s_mov_b32 s44, s16
    s_and_b32 s45, s17, 0xffff
    s_mov_b32 s46, 2097152
    s_mov_b32 s47, 0x00020000
    s_mov_b32 s48, s30
    s_and_b32 s49, s31, 0xffff
    s_mov_b32 s50, 1409024
    s_mov_b32 s51, 0x00020000
    s_mov_b32 s52, s32
    s_and_b32 s53, s33, 0xffff
    s_mov_b32 s54, 1409024
    s_mov_b32 s55, 0x00020000
    s_cmp_ge_u32 s60, 8
    s_cselect_b32 s76, s52, s48
    s_cselect_b32 s77, s53, s49
    s_mov_b32 s78, 1409024
    s_mov_b32 s79, 0x00020000
    buffer_load_dwordx4 v[16:19], v8, s[76:79], s3 offen
    buffer_load_dwordx4 v[32:35], v9, s[44:47], s4 offen
    s_add_u32 s3, s3, 44032
    s_add_u32 s4, s4, 8192
    buffer_load_dwordx4 v[20:23], v8, s[76:79], s3 offen
    buffer_load_dwordx4 v[36:39], v9, s[44:47], s4 offen
    s_add_u32 s3, s3, 44032
    s_add_u32 s4, s4, 8192
    buffer_load_dwordx4 v[24:27], v8, s[76:79], s3 offen
    buffer_load_dwordx4 v[40:43], v9, s[44:47], s4 offen
    s_add_u32 s3, s3, 44032
    s_add_u32 s4, s4, 8192
    buffer_load_dwordx4 v[28:31], v8, s[76:79], s3 offen
    buffer_load_dwordx4 v[44:47], v9, s[44:47], s4 offen
    s_add_u32 m0, s68, 32768
    s_add_u32 s63, s67, 0
    buffer_load_dwordx4 v10, s[44:47], s63 offen lds
    s_add_u32 m0, s68, 33792
    s_add_u32 s63, s67, 8192
    buffer_load_dwordx4 v11, s[44:47], s63 offen lds
    s_add_u32 m0, s68, 34816
    s_add_u32 s63, s67, 16384
    buffer_load_dwordx4 v10, s[44:47], s63 offen lds
    s_add_u32 m0, s68, 35840
    s_add_u32 s63, s67, 24576
    buffer_load_dwordx4 v11, s[44:47], s63 offen lds
    s_add_u32 s63, s66, 0
    s_add_u32 m0, s68, 0
    buffer_load_dwordx4 v12, s[48:51], s63 offen lds
    s_add_u32 m0, s68, 16384
    buffer_load_dwordx4 v12, s[52:55], s63 offen lds
    s_add_u32 s63, s66, 11008
    s_add_u32 m0, s68, 1024
    buffer_load_dwordx4 v12, s[48:51], s63 offen lds
    s_add_u32 m0, s68, 17408
    buffer_load_dwordx4 v12, s[52:55], s63 offen lds
    s_add_u32 s63, s66, 22016
    s_add_u32 m0, s68, 2048
    buffer_load_dwordx4 v12, s[48:51], s63 offen lds
    s_add_u32 m0, s68, 18432
    buffer_load_dwordx4 v12, s[52:55], s63 offen lds
    s_add_u32 s63, s66, 33024
    s_add_u32 m0, s68, 3072
    buffer_load_dwordx4 v12, s[48:51], s63 offen lds
    s_add_u32 m0, s68, 19456
    buffer_load_dwordx4 v12, s[52:55], s63 offen lds
    s_add_u32 m0, s68, 81920
    s_add_u32 s63, s67, 128
    buffer_load_dwordx4 v10, s[44:47], s63 offen lds
    s_add_u32 m0, s68, 82944
    s_add_u32 s63, s67, 8320
    buffer_load_dwordx4 v11, s[44:47], s63 offen lds
    s_add_u32 m0, s68, 83968
    s_add_u32 s63, s67, 16512
    buffer_load_dwordx4 v10, s[44:47], s63 offen lds
    s_add_u32 m0, s68, 84992
    s_add_u32 s63, s67, 24704
    buffer_load_dwordx4 v11, s[44:47], s63 offen lds
    s_add_u32 s63, s66, 176128
    s_add_u32 m0, s68, 49152
    buffer_load_dwordx4 v12, s[48:51], s63 offen lds
    s_add_u32 m0, s68, 65536
    buffer_load_dwordx4 v12, s[52:55], s63 offen lds
    s_add_u32 s63, s66, 187136
    s_add_u32 m0, s68, 50176
    buffer_load_dwordx4 v12, s[48:51], s63 offen lds
    s_add_u32 m0, s68, 66560
    buffer_load_dwordx4 v12, s[52:55], s63 offen lds
    s_add_u32 s63, s66, 198144
    s_add_u32 m0, s68, 51200
    buffer_load_dwordx4 v12, s[48:51], s63 offen lds
    s_add_u32 m0, s68, 67584
    buffer_load_dwordx4 v12, s[52:55], s63 offen lds
    s_add_u32 s63, s66, 209152
    s_add_u32 m0, s68, 52224
    buffer_load_dwordx4 v12, s[48:51], s63 offen lds
    s_add_u32 m0, s68, 68608
    buffer_load_dwordx4 v12, s[52:55], s63 offen lds
    s_mov_b32 s56, s40
    s_and_b32 s57, s41, 0xffff
    s_mov_b32 s58, 16777216
    s_mov_b32 s59, 0x00020000
    v_mov_b32 v4, 0
    v_mov_b32 v5, 0
    v_mov_b32 v6, 0
    v_mov_b32 v7, 163328
    ds_write_b96 v7, v[4:6]
    s_lshl_b32 s70, s2, 8
    s_add_u32 s70, s70, 9437248
    s_lshr_b32 s63, s65, 1
    s_lshl_b32 s63, s63, 3
    s_lshl_b32 s69, 0xff, s63
    s_or_b32 s69, s69, 0xff0000
    v_cmp_gt_u32 vcc, 16, v1
    v_mov_b32 v2, s60
    v_mov_b32 v3, s61
    v_subrev_u32 v4, 16, v1
    v_cndmask_b32 v2, v2, v1, vcc
    v_cndmask_b32 v3, v4, v3, vcc
    v_lshrrev_b32 v4, 3, v2
    v_mul_u32_u24 v4, 88, v4
    v_lshl_add_u32 v4, v3, 3, v4
    v_and_b32 v2, 7, v2
    v_add_u32 v4, v4, v2
    v_mul_u32_u24 v2, 2979, v4
    v_lshrrev_b32 v2, 16, v2
    v_mul_u32_u24 v3, 22, v2
    v_sub_u32 v3, v4, v3
    v_lshl_add_u32 v2, v3, 3, v2
    v_lshlrev_b32 v2, 8, v2
    s_add_u32 s63, s60, 9453632
    s_add_u32 s64, s61, 9453648
    v_mov_b32 v3, s64
    v_mov_b32 v4, s63
    v_cndmask_b32 v3, v3, v4, vcc
    v_add_u32 v13, v2, v3
    s_cmp_lt_u32 s61, 8
    s_mov_b32 s72, 0xffff
    s_cselect_b32 s72, 0x7ffffff, s72
    s_cmp_eq_u32 s65, 0
    s_cselect_b32 s72, s72, 0
    s_mov_b32 s73, 0
    s_waitcnt vmcnt(12) lgkmcnt(0)
    s_barrier
    s_add_u32 m0, s68, 131072
    s_add_u32 s63, s67, 256
    buffer_load_dwordx4 v10, s[44:47], s63 offen lds
    s_add_u32 m0, s68, 132096
    s_add_u32 s63, s67, 8448
    buffer_load_dwordx4 v11, s[44:47], s63 offen lds
    s_add_u32 m0, s68, 133120
    s_add_u32 s63, s67, 16640
    buffer_load_dwordx4 v10, s[44:47], s63 offen lds
    s_add_u32 m0, s68, 134144
    s_add_u32 s63, s67, 24832
    buffer_load_dwordx4 v11, s[44:47], s63 offen lds
    s_add_u32 s63, s66, 352256
    s_add_u32 m0, s68, 98304
    buffer_load_dwordx4 v12, s[48:51], s63 offen lds
    s_add_u32 m0, s68, 114688
    buffer_load_dwordx4 v12, s[52:55], s63 offen lds
    s_add_u32 s63, s66, 363264
    s_add_u32 m0, s68, 99328
    buffer_load_dwordx4 v12, s[48:51], s63 offen lds
    s_add_u32 m0, s68, 115712
    buffer_load_dwordx4 v12, s[52:55], s63 offen lds
    s_add_u32 s63, s66, 374272
    s_add_u32 m0, s68, 100352
    buffer_load_dwordx4 v12, s[48:51], s63 offen lds
    s_add_u32 m0, s68, 116736
    buffer_load_dwordx4 v12, s[52:55], s63 offen lds
    s_add_u32 s63, s66, 385280
    s_add_u32 m0, s68, 101376
    buffer_load_dwordx4 v12, s[48:51], s63 offen lds
    s_add_u32 m0, s68, 117760
    buffer_load_dwordx4 v12, s[52:55], s63 offen lds
    s_waitcnt vmcnt(12)
    s_barrier
    s_add_u32 m0, s68, 32768
    s_add_u32 s63, s67, 384
    buffer_load_dwordx4 v10, s[44:47], s63 offen lds
    s_add_u32 m0, s68, 33792
    s_add_u32 s63, s67, 8576
    buffer_load_dwordx4 v11, s[44:47], s63 offen lds
    s_add_u32 m0, s68, 34816
    s_add_u32 s63, s67, 16768
    buffer_load_dwordx4 v10, s[44:47], s63 offen lds
    s_add_u32 m0, s68, 35840
    s_add_u32 s63, s67, 24960
    buffer_load_dwordx4 v11, s[44:47], s63 offen lds
    s_add_u32 s63, s66, 528384
    s_add_u32 m0, s68, 0
    buffer_load_dwordx4 v12, s[48:51], s63 offen lds
    s_add_u32 m0, s68, 16384
    buffer_load_dwordx4 v12, s[52:55], s63 offen lds
    s_add_u32 s63, s66, 539392
    s_add_u32 m0, s68, 1024
    buffer_load_dwordx4 v12, s[48:51], s63 offen lds
    s_add_u32 m0, s68, 17408
    buffer_load_dwordx4 v12, s[52:55], s63 offen lds
    s_add_u32 s63, s66, 550400
    s_add_u32 m0, s68, 2048
    buffer_load_dwordx4 v12, s[48:51], s63 offen lds
    s_add_u32 m0, s68, 18432
    buffer_load_dwordx4 v12, s[52:55], s63 offen lds
    s_add_u32 s63, s66, 561408
    s_add_u32 m0, s68, 3072
    buffer_load_dwordx4 v12, s[48:51], s63 offen lds
    s_add_u32 m0, s68, 19456
    buffer_load_dwordx4 v12, s[52:55], s63 offen lds
    s_waitcnt vmcnt(48)
    s_load_dword s82, s[38:39], 16
    v_lshlrev_b32 v64, 16, v16
    v_and_b32 v65, 0xffff0000, v16
    v_lshlrev_b32 v66, 16, v17
    v_and_b32 v67, 0xffff0000, v17
    v_lshlrev_b32 v68, 16, v18
    v_and_b32 v69, 0xffff0000, v18
    v_lshlrev_b32 v70, 16, v19
    v_and_b32 v71, 0xffff0000, v19
    v_lshlrev_b32 v72, 16, v20
    v_and_b32 v73, 0xffff0000, v20
    v_lshlrev_b32 v74, 16, v21
    v_and_b32 v75, 0xffff0000, v21
    v_lshlrev_b32 v76, 16, v22
    v_and_b32 v77, 0xffff0000, v22
    v_lshlrev_b32 v78, 16, v23
    v_and_b32 v79, 0xffff0000, v23
    v_lshlrev_b32 v80, 16, v24
    v_and_b32 v81, 0xffff0000, v24
    v_lshlrev_b32 v82, 16, v25
    v_and_b32 v83, 0xffff0000, v25
    v_lshlrev_b32 v84, 16, v26
    v_and_b32 v85, 0xffff0000, v26
    v_lshlrev_b32 v86, 16, v27
    v_and_b32 v87, 0xffff0000, v27
    v_lshlrev_b32 v88, 16, v28
    v_and_b32 v89, 0xffff0000, v28
    v_lshlrev_b32 v90, 16, v29
    v_and_b32 v91, 0xffff0000, v29
    v_lshlrev_b32 v92, 16, v30
    v_and_b32 v93, 0xffff0000, v30
    v_lshlrev_b32 v94, 16, v31
    v_and_b32 v95, 0xffff0000, v31
    v_add_f32 v64, v64, v72
    v_add_f32 v65, v65, v73
    v_add_f32 v80, v80, v88
    v_add_f32 v81, v81, v89
    v_add_f32 v66, v66, v74
    v_add_f32 v67, v67, v75
    v_add_f32 v82, v82, v90
    v_add_f32 v83, v83, v91
    v_add_f32 v68, v68, v76
    v_add_f32 v69, v69, v77
    v_add_f32 v84, v84, v92
    v_add_f32 v85, v85, v93
    v_add_f32 v70, v70, v78
    v_add_f32 v71, v71, v79
    v_add_f32 v86, v86, v94
    v_add_f32 v87, v87, v95
    v_add_f32 v64, v64, v80
    v_add_f32 v65, v65, v81
    v_add_f32 v66, v66, v82
    v_add_f32 v67, v67, v83
    v_add_f32 v68, v68, v84
    v_add_f32 v69, v69, v85
    v_add_f32 v70, v70, v86
    v_add_f32 v71, v71, v87
    s_nop 1
    v_permlane32_swap_b32 v64, v68
    v_permlane32_swap_b32 v65, v69
    v_permlane32_swap_b32 v66, v70
    v_permlane32_swap_b32 v67, v71
    s_nop 1
    v_add_f32 v64, v64, v68
    v_add_f32 v65, v65, v69
    v_add_f32 v66, v66, v70
    v_add_f32 v67, v67, v71
    s_nop 1
    v_permlane16_swap_b32 v64, v66
    v_permlane16_swap_b32 v65, v67
    s_nop 1
    v_add_f32 v64, v64, v66
    v_add_f32 v65, v65, v67
    s_nop 1
    v_add_f32_dpp v64, v64, v64 row_ror:4 row_mask:0xf bank_mask:0xf
    v_add_f32_dpp v65, v65, v65 row_ror:4 row_mask:0xf bank_mask:0xf
    s_nop 1
    v_add_f32_dpp v64, v64, v64 row_ror:8 row_mask:0xf bank_mask:0xf
    v_add_f32_dpp v65, v65, v65 row_ror:8 row_mask:0xf bank_mask:0xf
    v_and_b32 v2, 3, v1
    v_lshrrev_b32 v3, 4, v1
    v_lshlrev_b32 v3, 3, v3
    v_lshl_add_u32 v2, v2, 5, v3
    s_lshl_b32 s63, s61, 4
    s_add_u32 s63, s63, s60
    s_lshl_b32 s63, s63, 9
    s_lshl_b32 s64, s65, 7
    s_add_u32 s63, s63, s64
    s_add_u32 s63, s63, 8912896
    s_mov_b32 exec_lo, 0x000f000f
    s_mov_b32 exec_hi, 0x000f000f
    buffer_store_dwordx2 v[64:65], v2, s[56:59], s63 offen sc1
    s_mov_b64 exec, -1
    s_waitcnt vmcnt(13)
    s_barrier
    s_add_u32 m0, s68, 81920
    s_add_u32 s63, s67, 512
    buffer_load_dwordx4 v10, s[44:47], s63 offen lds
    s_add_u32 m0, s68, 82944
    s_add_u32 s63, s67, 8704
    buffer_load_dwordx4 v11, s[44:47], s63 offen lds
    s_add_u32 m0, s68, 83968
    s_add_u32 s63, s67, 16896
    buffer_load_dwordx4 v10, s[44:47], s63 offen lds
    s_add_u32 m0, s68, 84992
    s_add_u32 s63, s67, 25088
    buffer_load_dwordx4 v11, s[44:47], s63 offen lds
    s_add_u32 s63, s66, 704512
    s_add_u32 m0, s68, 49152
    buffer_load_dwordx4 v12, s[48:51], s63 offen lds
    s_add_u32 m0, s68, 65536
    buffer_load_dwordx4 v12, s[52:55], s63 offen lds
    s_add_u32 s63, s66, 715520
    s_add_u32 m0, s68, 50176
    buffer_load_dwordx4 v12, s[48:51], s63 offen lds
    s_add_u32 m0, s68, 66560
    buffer_load_dwordx4 v12, s[52:55], s63 offen lds
    s_add_u32 s63, s66, 726528
    s_add_u32 m0, s68, 51200
    buffer_load_dwordx4 v12, s[48:51], s63 offen lds
    s_add_u32 m0, s68, 67584
    buffer_load_dwordx4 v12, s[52:55], s63 offen lds
    s_add_u32 s63, s66, 737536
    s_add_u32 m0, s68, 52224
    buffer_load_dwordx4 v12, s[48:51], s63 offen lds
    s_add_u32 m0, s68, 68608
    buffer_load_dwordx4 v12, s[52:55], s63 offen lds
    v_lshlrev_b32 v72, 16, v32
    v_and_b32 v73, 0xffff0000, v32
    v_lshlrev_b32 v74, 16, v33
    v_and_b32 v75, 0xffff0000, v33
    v_lshlrev_b32 v76, 16, v34
    v_and_b32 v77, 0xffff0000, v34
    v_lshlrev_b32 v78, 16, v35
    v_and_b32 v79, 0xffff0000, v35
    v_lshlrev_b32 v80, 16, v36
    v_and_b32 v81, 0xffff0000, v36
    v_lshlrev_b32 v82, 16, v37
    v_and_b32 v83, 0xffff0000, v37
    v_lshlrev_b32 v84, 16, v38
    v_and_b32 v85, 0xffff0000, v38
    v_lshlrev_b32 v86, 16, v39
    v_and_b32 v87, 0xffff0000, v39
    v_lshlrev_b32 v88, 16, v40
    v_and_b32 v89, 0xffff0000, v40
    v_lshlrev_b32 v90, 16, v41
    v_and_b32 v91, 0xffff0000, v41
    v_lshlrev_b32 v92, 16, v42
    v_and_b32 v93, 0xffff0000, v42
    v_lshlrev_b32 v94, 16, v43
    v_and_b32 v95, 0xffff0000, v43
    v_lshlrev_b32 v96, 16, v44
    v_and_b32 v97, 0xffff0000, v44
    v_lshlrev_b32 v98, 16, v45
    v_and_b32 v99, 0xffff0000, v45
    v_lshlrev_b32 v100, 16, v46
    v_and_b32 v101, 0xffff0000, v46
    v_lshlrev_b32 v102, 16, v47
    v_and_b32 v103, 0xffff0000, v47
    v_mul_f32 v32, v72, v72
    v_mul_f32 v33, v73, v73
    v_fma_f32 v32, v74, v74, v32
    v_fma_f32 v33, v75, v75, v33
    v_fma_f32 v32, v76, v76, v32
    v_fma_f32 v33, v77, v77, v33
    v_fma_f32 v32, v78, v78, v32
    v_fma_f32 v33, v79, v79, v33
    v_add_f32 v72, v72, v74
    v_add_f32 v73, v73, v75
    v_add_f32 v76, v76, v78
    v_add_f32 v77, v77, v79
    v_add_f32 v72, v72, v76
    v_add_f32 v73, v73, v77
    v_add_f32 v112, v72, v73
    v_add_f32 v113, v32, v33
    v_mul_f32 v36, v80, v80
    v_mul_f32 v37, v81, v81
    v_fma_f32 v36, v82, v82, v36
    v_fma_f32 v37, v83, v83, v37
    v_fma_f32 v36, v84, v84, v36
    v_fma_f32 v37, v85, v85, v37
    v_fma_f32 v36, v86, v86, v36
    v_fma_f32 v37, v87, v87, v37
    v_add_f32 v80, v80, v82
    v_add_f32 v81, v81, v83
    v_add_f32 v84, v84, v86
    v_add_f32 v85, v85, v87
    v_add_f32 v80, v80, v84
    v_add_f32 v81, v81, v85
    v_add_f32 v114, v80, v81
    v_add_f32 v115, v36, v37
    v_mul_f32 v40, v88, v88
    v_mul_f32 v41, v89, v89
    v_fma_f32 v40, v90, v90, v40
    v_fma_f32 v41, v91, v91, v41
    v_fma_f32 v40, v92, v92, v40
    v_fma_f32 v41, v93, v93, v41
    v_fma_f32 v40, v94, v94, v40
    v_fma_f32 v41, v95, v95, v41
    v_add_f32 v88, v88, v90
    v_add_f32 v89, v89, v91
    v_add_f32 v92, v92, v94
    v_add_f32 v93, v93, v95
    v_add_f32 v88, v88, v92
    v_add_f32 v89, v89, v93
    v_add_f32 v116, v88, v89
    v_add_f32 v117, v40, v41
    v_mul_f32 v44, v96, v96
    v_mul_f32 v45, v97, v97
    v_fma_f32 v44, v98, v98, v44
    v_fma_f32 v45, v99, v99, v45
    v_fma_f32 v44, v100, v100, v44
    v_fma_f32 v45, v101, v101, v45
    v_fma_f32 v44, v102, v102, v44
    v_fma_f32 v45, v103, v103, v45
    v_add_f32 v96, v96, v98
    v_add_f32 v97, v97, v99
    v_add_f32 v100, v100, v102
    v_add_f32 v101, v101, v103
    v_add_f32 v96, v96, v100
    v_add_f32 v97, v97, v101
    v_add_f32 v118, v96, v97
    v_add_f32 v119, v44, v45
    s_nop 1
    v_add_f32_dpp v112, v112, v112 quad_perm:[1,0,3,2] row_mask:0xf bank_mask:0xf
    v_add_f32_dpp v113, v113, v113 quad_perm:[1,0,3,2] row_mask:0xf bank_mask:0xf
    v_add_f32_dpp v114, v114, v114 quad_perm:[1,0,3,2] row_mask:0xf bank_mask:0xf
    v_add_f32_dpp v115, v115, v115 quad_perm:[1,0,3,2] row_mask:0xf bank_mask:0xf
    v_add_f32_dpp v116, v116, v116 quad_perm:[1,0,3,2] row_mask:0xf bank_mask:0xf
    v_add_f32_dpp v117, v117, v117 quad_perm:[1,0,3,2] row_mask:0xf bank_mask:0xf
    v_add_f32_dpp v118, v118, v118 quad_perm:[1,0,3,2] row_mask:0xf bank_mask:0xf
    v_add_f32_dpp v119, v119, v119 quad_perm:[1,0,3,2] row_mask:0xf bank_mask:0xf
    s_nop 1
    v_add_f32_dpp v112, v112, v112 quad_perm:[2,3,0,1] row_mask:0xf bank_mask:0xf
    v_add_f32_dpp v113, v113, v113 quad_perm:[2,3,0,1] row_mask:0xf bank_mask:0xf
    v_add_f32_dpp v114, v114, v114 quad_perm:[2,3,0,1] row_mask:0xf bank_mask:0xf
    v_add_f32_dpp v115, v115, v115 quad_perm:[2,3,0,1] row_mask:0xf bank_mask:0xf
    v_add_f32_dpp v116, v116, v116 quad_perm:[2,3,0,1] row_mask:0xf bank_mask:0xf
    v_add_f32_dpp v117, v117, v117 quad_perm:[2,3,0,1] row_mask:0xf bank_mask:0xf
    v_add_f32_dpp v118, v118, v118 quad_perm:[2,3,0,1] row_mask:0xf bank_mask:0xf
    v_add_f32_dpp v119, v119, v119 quad_perm:[2,3,0,1] row_mask:0xf bank_mask:0xf
    s_nop 1
    v_add_f32_dpp v112, v112, v112 row_half_mirror row_mask:0xf bank_mask:0xf
    v_add_f32_dpp v113, v113, v113 row_half_mirror row_mask:0xf bank_mask:0xf
    v_add_f32_dpp v114, v114, v114 row_half_mirror row_mask:0xf bank_mask:0xf
    v_add_f32_dpp v115, v115, v115 row_half_mirror row_mask:0xf bank_mask:0xf
    v_add_f32_dpp v116, v116, v116 row_half_mirror row_mask:0xf bank_mask:0xf
    v_add_f32_dpp v117, v117, v117 row_half_mirror row_mask:0xf bank_mask:0xf
    v_add_f32_dpp v118, v118, v118 row_half_mirror row_mask:0xf bank_mask:0xf
    v_add_f32_dpp v119, v119, v119 row_half_mirror row_mask:0xf bank_mask:0xf
    v_and_b32 v2, 7, v1
    v_cmp_eq_u32 vcc, 1, v2
    v_cndmask_b32 v112, v112, v114, vcc
    v_cndmask_b32 v113, v113, v115, vcc
    v_cmp_eq_u32 vcc, 2, v2
    v_cndmask_b32 v112, v112, v116, vcc
    v_cndmask_b32 v113, v113, v117, vcc
    v_cmp_eq_u32 vcc, 3, v2
    v_cndmask_b32 v112, v112, v118, vcc
    v_cndmask_b32 v113, v113, v119, vcc
    v_lshrrev_b32 v3, 3, v1
    v_lshl_add_u32 v2, v2, 3, v3
    v_lshlrev_b32 v2, 3, v2
    s_lshl_b32 s63, s60, 4
    s_add_u32 s63, s63, s61
    s_lshl_b32 s63, s63, 10
    s_lshl_b32 s64, s65, 8
    s_add_u32 s63, s63, s64
    s_add_u32 s63, s63, 9175040
    s_mov_b32 exec_lo, 0x0f0f0f0f
    s_mov_b32 exec_hi, 0x0f0f0f0f
    buffer_store_dwordx2 v[112:113], v2, s[56:59], s63 offen sc1
    s_mov_b64 exec, -1
    s_waitcnt lgkmcnt(0)
    s_waitcnt vmcnt(0)
    s_barrier
    s_cmp_ge_u32 s82, 1
    s_cbranch_scc1 sig_go5
    s_mov_b32 s84, s38
    s_and_b32 s85, s39, 0xffff
    s_mov_b32 s86, 256
    s_mov_b32 s87, 0x00020000
    v_mov_b32 v15, 16
    s_mov_b32 s80, 0
zp5:
    buffer_load_dword v14, v15, s[84:87], 0 offen sc1
    s_waitcnt vmcnt(0)
    v_readfirstlane_b32 s81, v14
    s_nop 3
    s_add_u32 s80, s80, 1
    s_cmp_ge_u32 s81, 1
    s_cbranch_scc1 zd5
    s_sleep 8
    s_cmp_lt_u32 s80, 0x40000
    s_cbranch_scc1 zp5
zd5:
    s_mov_b32 s82, 1
sig_go5:
    v_mov_b32 v2, 1
    s_mov_b64 exec, s[72:73]
    buffer_store_byte v2, v13, s[56:59], 0 offen sc1
    s_mov_b64 exec, -1
    s_add_u32 m0, s68, 131072
    s_add_u32 s63, s67, 640
    buffer_load_dwordx4 v10, s[44:47], s63 offen lds
    s_add_u32 m0, s68, 132096
    s_add_u32 s63, s67, 8832
    buffer_load_dwordx4 v11, s[44:47], s63 offen lds
    s_add_u32 m0, s68, 133120
    s_add_u32 s63, s67, 17024
    buffer_load_dwordx4 v10, s[44:47], s63 offen lds
    s_add_u32 m0, s68, 134144
    s_add_u32 s63, s67, 25216
    buffer_load_dwordx4 v11, s[44:47], s63 offen lds
    s_add_u32 s63, s66, 880640
    s_add_u32 m0, s68, 98304
    buffer_load_dwordx4 v12, s[48:51], s63 offen lds
    s_add_u32 m0, s68, 114688
    buffer_load_dwordx4 v12, s[52:55], s63 offen lds
    s_add_u32 s63, s66, 891648
    s_add_u32 m0, s68, 99328
    buffer_load_dwordx4 v12, s[48:51], s63 offen lds
    s_add_u32 m0, s68, 115712
    buffer_load_dwordx4 v12, s[52:55], s63 offen lds
    s_add_u32 s63, s66, 902656
    s_add_u32 m0, s68, 100352
    buffer_load_dwordx4 v12, s[48:51], s63 offen lds
    s_add_u32 m0, s68, 116736
    buffer_load_dwordx4 v12, s[52:55], s63 offen lds
    s_add_u32 s63, s66, 913664
    s_add_u32 m0, s68, 101376
    buffer_load_dwordx4 v12, s[48:51], s63 offen lds
    s_add_u32 m0, s68, 117760
    buffer_load_dwordx4 v12, s[52:55], s63 offen lds
    s_waitcnt vmcnt(14)
    s_barrier
    buffer_load_ubyte v8, v1, s[56:59], s70 offen sc1
    s_add_u32 m0, s68, 32768
    s_add_u32 s63, s67, 768
    buffer_load_dwordx4 v10, s[44:47], s63 offen lds
    s_add_u32 m0, s68, 33792
    s_add_u32 s63, s67, 8960
    buffer_load_dwordx4 v11, s[44:47], s63 offen lds
    s_add_u32 m0, s68, 34816
    s_add_u32 s63, s67, 17152
    buffer_load_dwordx4 v10, s[44:47], s63 offen lds
    s_add_u32 m0, s68, 35840
    s_add_u32 s63, s67, 25344
    buffer_load_dwordx4 v11, s[44:47], s63 offen lds
    s_add_u32 s63, s66, 1056768
    s_add_u32 m0, s68, 0
    buffer_load_dwordx4 v12, s[48:51], s63 offen lds
    s_add_u32 m0, s68, 16384
    buffer_load_dwordx4 v12, s[52:55], s63 offen lds
    s_add_u32 s63, s66, 1067776
    s_add_u32 m0, s68, 1024
    buffer_load_dwordx4 v12, s[48:51], s63 offen lds
    s_add_u32 m0, s68, 17408
    buffer_load_dwordx4 v12, s[52:55], s63 offen lds
    s_add_u32 s63, s66, 1078784
    s_add_u32 m0, s68, 2048
    buffer_load_dwordx4 v12, s[48:51], s63 offen lds
    s_add_u32 m0, s68, 18432
    buffer_load_dwordx4 v12, s[52:55], s63 offen lds
    s_add_u32 s63, s66, 1089792
    s_add_u32 m0, s68, 3072
    buffer_load_dwordx4 v12, s[48:51], s63 offen lds
    s_add_u32 m0, s68, 19456
    buffer_load_dwordx4 v12, s[52:55], s63 offen lds
    s_waitcnt vmcnt(13)
    s_barrier
    s_add_u32 m0, s68, 81920
    s_add_u32 s63, s67, 896
    buffer_load_dwordx4 v10, s[44:47], s63 offen lds
    s_add_u32 m0, s68, 82944
    s_add_u32 s63, s67, 9088
    buffer_load_dwordx4 v11, s[44:47], s63 offen lds
    s_add_u32 m0, s68, 83968
    s_add_u32 s63, s67, 17280
    buffer_load_dwordx4 v10, s[44:47], s63 offen lds
    s_add_u32 m0, s68, 84992
    s_add_u32 s63, s67, 25472
    buffer_load_dwordx4 v11, s[44:47], s63 offen lds
    s_add_u32 s63, s66, 1232896
    s_add_u32 m0, s68, 49152
    buffer_load_dwordx4 v12, s[48:51], s63 offen lds
    s_add_u32 m0, s68, 65536
    buffer_load_dwordx4 v12, s[52:55], s63 offen lds
    s_add_u32 s63, s66, 1243904
    s_add_u32 m0, s68, 50176
    buffer_load_dwordx4 v12, s[48:51], s63 offen lds
    s_add_u32 m0, s68, 66560
    buffer_load_dwordx4 v12, s[52:55], s63 offen lds
    s_add_u32 s63, s66, 1254912
    s_add_u32 m0, s68, 51200
    buffer_load_dwordx4 v12, s[48:51], s63 offen lds
    s_add_u32 m0, s68, 67584
    buffer_load_dwordx4 v12, s[52:55], s63 offen lds
    s_add_u32 s63, s66, 1265920
    s_add_u32 m0, s68, 52224
    buffer_load_dwordx4 v12, s[48:51], s63 offen lds
    s_add_u32 m0, s68, 68608
    buffer_load_dwordx4 v12, s[52:55], s63 offen lds
    s_waitcnt vmcnt(24)
    v_cmp_ne_u32 vcc, 0, v8
    s_and_b32 s81, vcc_lo, s69
    s_cmp_eq_u32 s81, s69
    s_cbranch_scc1 polled6
    s_mov_b32 s80, 0
poll6:
    buffer_load_ubyte v14, v1, s[56:59], s70 offen sc1
    s_waitcnt vmcnt(0)
    v_cmp_ne_u32 vcc, 0, v14
    s_add_u32 s80, s80, 1
    s_and_b32 s81, vcc_lo, s69
    s_cmp_eq_u32 s81, s69
    s_cbranch_scc1 polled6
    s_sleep 1
    s_cmp_lt_u32 s80, 0x40000
    s_cbranch_scc1 poll6
polled6:
    s_bfe_u32 s63, vcc_lo, 131096
    s_cmp_eq_u32 s63, 3
    s_cselect_b32 s43, -1, 0
    s_lshl_b32 s63, s61, 13
    s_lshr_b32 s64, s65, 1
    s_lshl_b32 s64, s64, 12
    s_add_u32 s63, s63, s64
    s_and_b32 s64, s65, 1
    s_lshl_b32 s64, s64, 8
    s_add_u32 s63, s63, s64
    s_add_u32 s63, s63, 8912896
    v_lshlrev_b32 v2, 2, v1
    buffer_load_dword v16, v2, s[56:59], s63 offen offset:0
    buffer_load_dword v17, v2, s[56:59], s63 offen offset:512
    buffer_load_dword v18, v2, s[56:59], s63 offen offset:1024
    buffer_load_dword v19, v2, s[56:59], s63 offen offset:1536
    buffer_load_dword v20, v2, s[56:59], s63 offen offset:2048
    buffer_load_dword v21, v2, s[56:59], s63 offen offset:2560
    buffer_load_dword v22, v2, s[56:59], s63 offen offset:3072
    buffer_load_dword v23, v2, s[56:59], s63 offen offset:3584
    s_lshl_b32 s63, s60, 14
    s_lshl_b32 s64, s65, 8
    s_add_u32 s63, s63, s64
    s_add_u32 s63, s63, 9175040
    s_add_u32 s64, s63, 4096
    v_and_b32 v2, 31, v1
    v_lshlrev_b32 v2, 3, v2
    buffer_load_dwordx2 v[24:25], v2, s[56:59], s63 offen offset:0
    buffer_load_dwordx2 v[26:27], v2, s[56:59], s63 offen offset:1024
    buffer_load_dwordx2 v[28:29], v2, s[56:59], s63 offen offset:2048
    buffer_load_dwordx2 v[30:31], v2, s[56:59], s63 offen offset:3072
    buffer_load_dwordx2 v[32:33], v2, s[56:59], s64 offen offset:0
    buffer_load_dwordx2 v[34:35], v2, s[56:59], s64 offen offset:1024
    buffer_load_dwordx2 v[36:37], v2, s[56:59], s64 offen offset:2048
    buffer_load_dwordx2 v[38:39], v2, s[56:59], s64 offen offset:3072
    s_lshr_b32 s3, s2, 5
    s_mul_i32 s3, s3, 180224
    s_add_u32 s3, s3, 10485760
    s_bfe_u32 s4, s2, 0x20003
    s_lshr_b32 s64, s2, 5
    s_add_u32 s4, s4, s64
    s_and_b32 s4, s4, 7
    s_mul_i32 s4, s4, 22528
    s_mul_i32 s63, s65, 5632
    s_add_u32 s4, s4, s63
    s_add_u32 s4, s4, s3
    s_add_u32 s63, s62, s64
    s_and_b32 s63, s63, 7
    s_mul_i32 s63, s63, 22528
    s_add_u32 s3, s3, s63
    v_lshlrev_b32 v9, 4, v1
    s_mov_b32 exec_lo, s43
    s_mov_b32 exec_hi, s43
    buffer_load_dwordx4 v[168:171], v9, s[56:59], s3 offen offset:0
    buffer_load_dwordx4 v[172:175], v9, s[56:59], s3 offen offset:1024
    s_mov_b64 exec, -1
    s_waitcnt vmcnt(30)
    s_barrier
    s_mov_b32 exec_lo, s43
    s_mov_b32 exec_hi, s43
    buffer_load_dwordx4 v[176:179], v9, s[56:59], s3 offen offset:2048
    buffer_load_dwordx4 v[180:183], v9, s[56:59], s3 offen offset:3072
    s_add_u32 s3, s3, 4096
    s_mov_b64 exec, -1
    s_cmp_lg_u32 s43, 0
    s_cbranch_scc1 k1h_wok
    s_mov_b32 s69, 50331648
    s_mov_b32 s80, 0
poll7:
    buffer_load_ubyte v14, v1, s[56:59], s70 offen sc1
    s_waitcnt vmcnt(0)
    v_cmp_ne_u32 vcc, 0, v14
    s_add_u32 s80, s80, 1
    s_and_b32 s81, vcc_lo, s69
    s_cmp_eq_u32 s81, s69
    s_cbranch_scc1 polled7
    s_sleep 1
    s_cmp_lt_u32 s80, 0x40000
    s_cbranch_scc1 poll7
polled7:
k1h_wok:
    s_lshr_b32 s63, s65, 1
    s_mul_i32 s5, s65, 11264
    s_add_u32 s63, s63, 0
    s_lshr_b32 s64, s2, 5
    s_add_u32 s63, s63, s64
    s_and_b32 s63, s63, 7
    s_mul_i32 s63, s63, 22528
    s_mul_i32 s64, s64, 180224
    s_add_u32 s63, s63, s64
    s_and_b32 s64, s65, 1
    s_mul_i32 s64, s64, 11264
    s_add_u32 s63, s63, s64
    s_add_u32 s63, s63, 10485760
    s_add_u32 m0, s5, 98304
    buffer_load_dwordx4 v9, s[56:59], s63 offen lds
    s_add_u32 s63, s63, 1024
    s_add_u32 m0, s5, 99328
    buffer_load_dwordx4 v9, s[56:59], s63 offen lds
    s_add_u32 s63, s63, 1024
    s_add_u32 m0, s5, 100352
    buffer_load_dwordx4 v9, s[56:59], s63 offen lds
    s_add_u32 s63, s63, 1024
    s_add_u32 m0, s5, 101376
    buffer_load_dwordx4 v9, s[56:59], s63 offen lds
    s_add_u32 s63, s63, 1024
    s_add_u32 m0, s5, 102400
    buffer_load_dwordx4 v9, s[56:59], s63 offen lds
    s_add_u32 s63, s63, 1024
    s_add_u32 m0, s5, 103424
    buffer_load_dwordx4 v9, s[56:59], s63 offen lds
    s_add_u32 s63, s63, 1024
    s_add_u32 m0, s5, 104448
    buffer_load_dwordx4 v9, s[56:59], s63 offen lds
    s_add_u32 s63, s63, 1024
    s_add_u32 m0, s5, 105472
    buffer_load_dwordx4 v9, s[56:59], s63 offen lds
    s_add_u32 s63, s63, 1024
    s_add_u32 m0, s5, 106496
    buffer_load_dwordx4 v9, s[56:59], s63 offen lds
    s_add_u32 s63, s63, 1024
    s_add_u32 m0, s5, 107520
    buffer_load_dwordx4 v9, s[56:59], s63 offen lds
    s_add_u32 s63, s63, 1024
    s_add_u32 m0, s5, 108544
    buffer_load_dwordx4 v9, s[56:59], s63 offen lds
    s_add_u32 s63, s63, 1024
    s_waitcnt vmcnt(15)
    v_add_f32 v16, v16, v17
    v_add_f32 v24, v24, v26
    v_add_f32 v25, v25, v27
    v_add_f32 v18, v18, v19
    v_add_f32 v28, v28, v30
    v_add_f32 v29, v29, v31
    v_add_f32 v20, v20, v21
    v_add_f32 v32, v32, v34
    v_add_f32 v33, v33, v35
    v_add_f32 v22, v22, v23
    v_add_f32 v36, v36, v38
    v_add_f32 v37, v37, v39
    v_add_f32 v16, v16, v18
    v_add_f32 v24, v24, v28
    v_add_f32 v25, v25, v29
    v_add_f32 v20, v20, v22
    v_add_f32 v32, v32, v36
    v_add_f32 v33, v33, v37
    v_add_f32 v16, v16, v20
    v_add_f32 v24, v24, v32
    v_add_f32 v25, v25, v33
    v_cvt_pk_bf16_f32 v4, 0, v16
    v_sub_f32 v16, v16, v4
    v_cvt_pk_bf16_f32 v5, 0, v16
    v_sub_f32 v16, v16, v5
    v_cvt_pk_bf16_f32 v41, v16, 0
    v_lshrrev_b32 v4, 16, v4
    v_or_b32 v40, v4, v5
    v_mov_b32 v42, 0
    v_mov_b32 v43, 0
    v_mov_b32 v44, 0
    v_mov_b32 v45, 0
    v_mov_b32 v46, 0
    v_mov_b32 v47, 0
    v_lshrrev_b32 v2, 5, v1
    v_and_b32 v3, 31, v1
    v_lshlrev_b32 v3, 4, v3
    v_lshl_add_u32 v2, v2, 10, v3
    s_lshl_b32 s63, s65, 11
    s_add_u32 s63, s63, 147456
    v_add_u32 v2, s63, v2
    ds_write_b128 v2, v[40:43]
    ds_write_b128 v2, v[44:47] offset:512
    v_mul_f32 v48, 0x3b000000, v24
    v_mul_f32 v50, 0x3b000000, v25
    v_fma_f32 v50, -v48, v48, v50
    v_max_f32 v50, 0, v50
    v_cvt_pk_bf16_f32 v49, v48, v50
    v_lshlrev_b32 v52, 16, v49
    v_and_b32 v50, 0xffff0000, v49
    v_add_f32 v50, 0x3727c5ac, v50
    v_cvt_pk_bf16_f32 v50, v50, v50
    v_and_b32 v50, 0xffff0000, v50
    v_sqrt_f32 v50, v50
    s_nop 0
    v_cvt_pk_bf16_f32 v50, v50, v50
    v_and_b32 v50, 0xffff0000, v50
    v_rcp_f32 v56, v50
    s_nop 0
    v_mul_f32 v57, v52, v56
    v_sub_f32 v57, 0, v57
    v_xor_b32 v4, 0x80000000, v52
    v_lshrrev_b32 v41, 16, v4
    v_or_b32 v40, v4, v41
    v_cmp_gt_u32 vcc, 32, v1
    v_cndmask_b32 v40, 0, v40, vcc
    v_cndmask_b32 v41, 0, v41, vcc
    s_lshl_b32 s63, s65, 10
    s_add_u32 s63, s63, 155648
    v_lshl_add_u32 v2, v1, 4, s63
    ds_write_b128 v2, v[40:43]
    s_lshl_b32 s63, s65, 7
    s_add_u32 s63, s63, 159744
    v_lshl_add_u32 v2, v1, 2, s63
    s_mov_b32 exec_hi, 0
    ds_write_b32 v2, v56
    s_lshl_b32 s63, s60, 10
    s_lshl_b32 s64, s65, 8
    s_add_u32 s63, s63, s64
    s_add_u32 s63, s63, 8388608
    v_lshlrev_b32 v2, 3, v1
    s_cmp_eq_u32 s61, 0
    s_cselect_b32 exec_lo, -1, 0
    buffer_store_dwordx2 v[56:57], v2, s[56:59], s63 offen sc1
    s_mov_b64 exec, -1
    s_waitcnt lgkmcnt(0)
    s_barrier
    s_mov_b32 exec_lo, s43
    s_mov_b32 exec_hi, s43
    s_mov_b64 exec, -1
    s_lshr_b32 s63, s65, 1
    s_mul_i32 s5, s65, 11264
    s_add_u32 s63, s63, 2
    s_lshr_b32 s64, s2, 5
    s_add_u32 s63, s63, s64
    s_and_b32 s63, s63, 7
    s_mul_i32 s63, s63, 22528
    s_mul_i32 s64, s64, 180224
    s_add_u32 s63, s63, s64
    s_and_b32 s64, s65, 1
    s_mul_i32 s64, s64, 11264
    s_add_u32 s63, s63, s64
    s_add_u32 s63, s63, 10485760
    s_add_u32 m0, s5, 0
    buffer_load_dwordx4 v9, s[56:59], s63 offen lds
    s_add_u32 s63, s63, 1024
    s_add_u32 m0, s5, 1024
    buffer_load_dwordx4 v9, s[56:59], s63 offen lds
    s_add_u32 s63, s63, 1024
    s_add_u32 m0, s5, 2048
    buffer_load_dwordx4 v9, s[56:59], s63 offen lds
    s_add_u32 s63, s63, 1024
    s_add_u32 m0, s5, 3072
    buffer_load_dwordx4 v9, s[56:59], s63 offen lds
    s_add_u32 s63, s63, 1024
    s_add_u32 m0, s5, 4096
    buffer_load_dwordx4 v9, s[56:59], s63 offen lds
    s_add_u32 s63, s63, 1024
    s_add_u32 m0, s5, 5120
    buffer_load_dwordx4 v9, s[56:59], s63 offen lds
    s_add_u32 s63, s63, 1024
    s_add_u32 m0, s5, 6144
    buffer_load_dwordx4 v9, s[56:59], s63 offen lds
    s_add_u32 s63, s63, 1024
    s_add_u32 m0, s5, 7168
    buffer_load_dwordx4 v9, s[56:59], s63 offen lds
    s_add_u32 s63, s63, 1024
    s_add_u32 m0, s5, 8192
    buffer_load_dwordx4 v9, s[56:59], s63 offen lds
    s_add_u32 s63, s63, 1024
    s_add_u32 m0, s5, 9216
    buffer_load_dwordx4 v9, s[56:59], s63 offen lds
    s_add_u32 s63, s63, 1024
    s_add_u32 m0, s5, 10240
    buffer_load_dwordx4 v9, s[56:59], s63 offen lds
    s_add_u32 s63, s63, 1024
    s_lshl_b32 s63, 1, s65
    v_mov_b32 v2, s63
    v_mov_b32 v3, 163328
    s_waitcnt vmcnt(0)
    s_mov_b64 exec, 1
    ds_or_b32 v3, v2 offset:8
    s_mov_b64 exec, -1
    s_lshl_b32 s63, s60, 1
    s_lshr_b32 s64, s65, 1
    s_add_u32 s63, s63, s64
    s_and_b32 s64, s65, 1
    s_add_u32 s64, s64, 24
    s_and_b32 s5, s63, 3
    s_lshl_b32 s5, s5, 3
    s_lshr_b32 s78, s63, 2
    s_add_u32 s78, s78, s5
    s_lshl_b32 s78, s78, 8
    s_add_u32 s78, s78, s64
    s_add_u32 s78, s78, 9437184
    s_mov_b32 s79, 13
    s_cmp_eq_u32 s61, 0
    s_cselect_b32 s42, 0xff, 0
    v_lshlrev_b32 v12, s79, v1
    v_mov_b32 v13, 1
    s_mov_b32 exec_lo, s42
    s_mov_b32 exec_hi, 0
    buffer_store_byte v13, v12, s[56:59], s78 offen sc1
    s_mov_b64 exec, -1
    s_mov_b32 s42, 0
    s_mov_b32 exec_lo, s43
    s_mov_b32 exec_hi, s43
    buffer_load_dwordx4 v[184:187], v9, s[56:59], s3 offen offset:0
    buffer_load_dwordx4 v[188:191], v9, s[56:59], s3 offen offset:1024
    buffer_load_dwordx4 v[192:195], v9, s[56:59], s3 offen offset:2048
    s_waitcnt vmcnt(2)
    buffer_load_dwordx4 v[196:199], v9, s[56:59], s3 offen offset:3072
    s_add_u32 s3, s3, 4096
    s_waitcnt vmcnt(2)
    buffer_load_dwordx4 v[200:203], v9, s[56:59], s3 offen offset:0
    s_waitcnt vmcnt(2)
    buffer_load_dwordx4 v[204:207], v9, s[56:59], s3 offen offset:1024
    s_waitcnt vmcnt(2)
    buffer_load_dwordx4 v[208:211], v9, s[56:59], s3 offen offset:2048
    s_waitcnt vmcnt(2)
    buffer_load_dwordx4 v[212:215], v9, s[56:59], s3 offen offset:3072
    s_add_u32 s3, s3, 4096
    s_waitcnt vmcnt(2)
    buffer_load_dwordx4 v[216:219], v9, s[56:59], s3 offen offset:0
    s_waitcnt vmcnt(2)
    buffer_load_dwordx4 v[220:223], v9, s[56:59], s3 offen offset:1024
    s_waitcnt vmcnt(2)
    buffer_load_dwordx4 v[224:227], v9, s[56:59], s3 offen offset:2048
    s_waitcnt vmcnt(2)
    buffer_load_dwordx4 v[228:231], v9, s[56:59], s3 offen offset:3072
    s_add_u32 s3, s3, 4096
    s_waitcnt vmcnt(2)
    buffer_load_dwordx4 v[232:235], v9, s[56:59], s3 offen offset:0
    s_waitcnt vmcnt(2)
    buffer_load_dwordx4 v[236:239], v9, s[56:59], s3 offen offset:1024
    s_waitcnt vmcnt(2)
    buffer_load_dwordx4 v[240:243], v9, s[56:59], s3 offen offset:2048
    s_waitcnt vmcnt(2)
    buffer_load_dwordx4 v[244:247], v9, s[56:59], s3 offen offset:3072
    s_add_u32 s3, s3, 4096
    s_waitcnt vmcnt(2)
    buffer_load_dwordx4 v[248:251], v9, s[56:59], s3 offen offset:0
    s_waitcnt vmcnt(2)
    buffer_load_dwordx4 v[252:255], v9, s[56:59], s3 offen offset:1024
    s_mov_b64 exec, -1
    s_mov_b32 s76, 1
    s_mov_b32 s77, 0
    s_branch g2_unit
k1_conv:
    v_lshrrev_b32 v2, 6, v0
    v_and_b32 v1, 63, v0
    v_readfirstlane_b32 s62, v2
    s_and_b32 s66, s2, 7
    s_lshr_b32 s67, s2, 3
    s_mov_b32 s60, s66
    v_lshrrev_b32 v2, 3, v0
    v_and_b32 v3, 7, v0
    s_lshl_b32 s63, s67, 18
    s_lshl_b32 s64, s60, 7
    s_add_u32 s63, s63, s64
    v_lshlrev_b32 v4, 12, v2
    v_lshl_add_u32 v4, v3, 4, v4
    v_add_u32 v4, s63, v4
    v_subrev_u32 v5, 3072, v4
    s_lshl_b32 s64, s60, 9
    v_lshlrev_b32 v6, 6, v3
    v_add_u32 v6, s64, v6
    s_waitcnt lgkmcnt(0)
    s_lshl_b32 s63, s60, 2
    s_lshr_b32 s63, 0x88881aaa, s63
    s_and_b32 s63, s63, 15
    s_cbranch_scc0 k1c_ns
k1c_sl:
    s_sleep 8
    s_sub_u32 s63, s63, 1
    s_cmp_lg_u32 s63, 0
    s_cbranch_scc1 k1c_sl
k1c_ns:
    s_mov_b32 s44, s18
    s_and_b32 s45, s19, 0xffff
    s_mov_b32 s46, 2097152
    s_mov_b32 s47, 0x00020000
    s_mov_b32 s48, s20
    s_and_b32 s49, s21, 0xffff
    s_mov_b32 s50, 2097152
    s_mov_b32 s51, 0x00020000
    s_mov_b32 s72, s22
    s_and_b32 s73, s23, 0xffff
    s_mov_b32 s74, 4096
    s_mov_b32 s75, 0x00020000
    buffer_load_dwordx4 v[16:19], v5, s[44:47], 0 offen offset:0
    buffer_load_dwordx4 v[20:23], v5, s[44:47], 0 offen offset:1024
    buffer_load_dwordx4 v[24:27], v5, s[44:47], 0 offen offset:2048
    buffer_load_dwordx4 v[28:31], v4, s[44:47], 0 offen offset:0
    buffer_load_dwordx4 v[32:35], v4, s[44:47], 0 offen offset:1024
    buffer_load_dwordx4 v[36:39], v4, s[44:47], 0 offen offset:2048
    buffer_load_dwordx4 v[40:43], v4, s[44:47], 0 offen offset:3072
    buffer_load_dwordx4 v[44:47], v4, s[48:51], 0 offen offset:0
    buffer_load_dwordx4 v[48:51], v4, s[48:51], 0 offen offset:1024
    buffer_load_dwordx4 v[52:55], v4, s[48:51], 0 offen offset:2048
    buffer_load_dwordx4 v[56:59], v4, s[48:51], 0 offen offset:3072
    buffer_load_dwordx4 v[60:63], v6, s[72:75], 0 offen offset:0
    buffer_load_dwordx4 v[64:67], v6, s[72:75], 0 offen offset:16
    buffer_load_dwordx4 v[68:71], v6, s[72:75], 0 offen offset:32
    buffer_load_dwordx4 v[72:75], v6, s[72:75], 0 offen offset:48
    s_mov_b32 s52, s24
    s_and_b32 s53, s25, 0xffff
    s_mov_b32 s54, 2097152
    s_mov_b32 s55, 0x00020000
    s_mov_b32 s56, s40
    s_and_b32 s57, s41, 0xffff
    s_mov_b32 s58, 16777216
    s_mov_b32 s59, 0x00020000
    s_lshl_b32 s68, s66, 3
    s_add_u32 s68, s68, s67
    s_lshl_b32 s68, s68, 3
    s_add_u32 s68, s68, s62
    s_lshl_b32 s70, s62, 14
    s_mul_i32 s63, s62, 12928
    s_add_u32 s63, s63, 13824
    s_cmp_ge_u32 s62, 4
    s_cselect_b32 s70, s63, s70
    s_add_u32 s69, s70, 8320
    s_lshl_b32 s63, s68, 1
    s_and_b32 s64, s63, 0xfffffffc
    s_add_u32 s26, s26, s64
    s_addc_u32 s27, s27, 0
    s_load_dword s65, s[26:27], 0
    s_lshl_b32 s68, s68, 12
    v_lshlrev_b32 v8, 4, v1
    v_mul_u32_u24 v7, 4224, v3
    v_lshlrev_b32 v9, 3, v2
    v_sub_u32 v7, v7, v9
    v_add_u32 v7, 117752, v7
    v_mov_b32 v12, -4
    v_mov_b32 v13, 0
    v_mov_b32 v14, 0
    v_mov_b32 v15, 163328
    ds_write_b96 v15, v[12:14]
    v_lshlrev_b32 v6, 3, v1
    v_add_u32 v6, s69, v6
    v_mov_b32 v10, 0
    v_mov_b32 v11, 0
    ds_write_b64 v6, v[10:11] offset:4096
    v_lshlrev_b32 v6, 2, v1
    v_add_u32 v6, s70, v6
    s_mov_b64 exec, 0xff
    ds_write_b32 v6, v10
    ds_write_b32 v6, v10 offset:4160
    s_mov_b64 exec, -1
    v_lshrrev_b32 v6, 5, v1
    v_and_b32 v10, 31, v1
    v_lshlrev_b32 v10, 4, v10
    v_mul_u32_u24 v9, 528, v6
    v_add_u32 v9, v9, v10
    s_mul_i32 s64, s62, 4224
    s_add_u32 s64, s64, 117248
    v_add_u32 v9, s64, v9
    v_lshl_add_u32 v10, v6, 12, v10
    s_lshl_b32 s3, s60, 18
    s_lshl_b32 s64, s62, 15
    s_add_u32 s3, s3, s64
    s_add_u32 s3, s3, 12586496
    s_lshl_b32 s64, s67, 9
    s_sub_u32 s3, s3, s64
    s_lshl_b32 s4, s62, 3
    s_add_u32 s4, s4, s60
    s_lshl_b32 s4, s4, 8
    s_add_u32 s4, s4, s67
    s_add_u32 s4, s4, 9437272
    s_lshl_b32 s71, s2, 8
    s_add_u32 s71, s71, 9437248
    s_mov_b32 s5, 4278190080
    s_waitcnt vmcnt(0)
    s_mov_b32 s84, s38
    s_and_b32 s85, s39, 0xffff
    s_mov_b32 s86, 256
    s_mov_b32 s87, 0x00020000
    buffer_load_dwordx4 v[232:235], v8, s[52:55], s68 offen offset:0
    buffer_load_dwordx4 v[236:239], v8, s[52:55], s68 offen offset:1024
    buffer_load_dwordx4 v[240:243], v8, s[52:55], s68 offen offset:2048
    buffer_load_dwordx4 v[244:247], v8, s[52:55], s68 offen offset:3072
    buffer_load_dword v248, v8, s[52:55], s68 offen offset:16
    buffer_load_dword v249, v8, s[52:55], s68 offen offset:1040
    buffer_load_dword v250, v8, s[52:55], s68 offen offset:2064
    buffer_load_dword v251, v8, s[52:55], s68 offen offset:3088
    v_lshlrev_b32 v200, 16, v60
    v_and_b32 v208, 0xffff0000, v60
    v_lshlrev_b32 v216, 16, v61
    v_and_b32 v224, 0xffff0000, v61
    v_lshlrev_b32 v201, 16, v62
    v_and_b32 v209, 0xffff0000, v62
    v_lshlrev_b32 v217, 16, v63
    v_and_b32 v225, 0xffff0000, v63
    v_lshlrev_b32 v202, 16, v64
    v_and_b32 v210, 0xffff0000, v64
    v_lshlrev_b32 v218, 16, v65
    v_and_b32 v226, 0xffff0000, v65
    v_lshlrev_b32 v203, 16, v66
    v_and_b32 v211, 0xffff0000, v66
    v_lshlrev_b32 v219, 16, v67
    v_and_b32 v227, 0xffff0000, v67
    v_lshlrev_b32 v204, 16, v68
    v_and_b32 v212, 0xffff0000, v68
    v_lshlrev_b32 v220, 16, v69
    v_and_b32 v228, 0xffff0000, v69
    v_lshlrev_b32 v205, 16, v70
    v_and_b32 v213, 0xffff0000, v70
    v_lshlrev_b32 v221, 16, v71
    v_and_b32 v229, 0xffff0000, v71
    v_lshlrev_b32 v206, 16, v72
    v_and_b32 v214, 0xffff0000, v72
    v_lshlrev_b32 v222, 16, v73
    v_and_b32 v230, 0xffff0000, v73
    v_lshlrev_b32 v207, 16, v74
    v_and_b32 v215, 0xffff0000, v74
    v_lshlrev_b32 v223, 16, v75
    v_and_b32 v231, 0xffff0000, v75
    v_lshlrev_b32 v80, 16, v16
    v_and_b32 v81, 0xffff0000, v16
    v_lshlrev_b32 v82, 16, v17
    v_and_b32 v83, 0xffff0000, v17
    v_lshlrev_b32 v84, 16, v18
    v_and_b32 v85, 0xffff0000, v18
    v_lshlrev_b32 v86, 16, v19
    v_and_b32 v87, 0xffff0000, v19
    v_lshlrev_b32 v88, 16, v20
    v_and_b32 v89, 0xffff0000, v20
    v_lshlrev_b32 v90, 16, v21
    v_and_b32 v91, 0xffff0000, v21
    v_lshlrev_b32 v92, 16, v22
    v_and_b32 v93, 0xffff0000, v22
    v_lshlrev_b32 v94, 16, v23
    v_and_b32 v95, 0xffff0000, v23
    v_lshlrev_b32 v96, 16, v24
    v_and_b32 v97, 0xffff0000, v24
    v_lshlrev_b32 v98, 16, v25
    v_and_b32 v99, 0xffff0000, v25
    v_lshlrev_b32 v100, 16, v26
    v_and_b32 v101, 0xffff0000, v26
    v_lshlrev_b32 v102, 16, v27
    v_and_b32 v103, 0xffff0000, v27
    v_lshlrev_b32 v104, 16, v28
    v_and_b32 v105, 0xffff0000, v28
    v_lshlrev_b32 v106, 16, v29
    v_and_b32 v107, 0xffff0000, v29
    v_lshlrev_b32 v108, 16, v30
    v_and_b32 v109, 0xffff0000, v30
    v_lshlrev_b32 v110, 16, v31
    v_and_b32 v111, 0xffff0000, v31
    v_lshlrev_b32 v112, 16, v32
    v_and_b32 v113, 0xffff0000, v32
    v_lshlrev_b32 v114, 16, v33
    v_and_b32 v115, 0xffff0000, v33
    v_lshlrev_b32 v116, 16, v34
    v_and_b32 v117, 0xffff0000, v34
    v_lshlrev_b32 v118, 16, v35
    v_and_b32 v119, 0xffff0000, v35
    v_lshlrev_b32 v120, 16, v36
    v_and_b32 v121, 0xffff0000, v36
    v_lshlrev_b32 v122, 16, v37
    v_and_b32 v123, 0xffff0000, v37
    v_lshlrev_b32 v124, 16, v38
    v_and_b32 v125, 0xffff0000, v38
    v_lshlrev_b32 v126, 16, v39
    v_and_b32 v127, 0xffff0000, v39
    v_lshlrev_b32 v128, 16, v40
    v_and_b32 v129, 0xffff0000, v40
    v_lshlrev_b32 v130, 16, v41
    v_and_b32 v131, 0xffff0000, v41
    v_lshlrev_b32 v132, 16, v42
    v_and_b32 v133, 0xffff0000, v42
    v_lshlrev_b32 v134, 16, v43
    v_and_b32 v135, 0xffff0000, v43
    v_lshlrev_b32 v136, 16, v44
    v_and_b32 v137, 0xffff0000, v44
    v_lshlrev_b32 v138, 16, v45
    v_and_b32 v139, 0xffff0000, v45
    v_lshlrev_b32 v140, 16, v46
    v_and_b32 v141, 0xffff0000, v46
    v_lshlrev_b32 v142, 16, v47
    v_and_b32 v143, 0xffff0000, v47
    v_lshlrev_b32 v144, 16, v48
    v_and_b32 v145, 0xffff0000, v48
    v_lshlrev_b32 v146, 16, v49
    v_and_b32 v147, 0xffff0000, v49
    v_lshlrev_b32 v148, 16, v50
    v_and_b32 v149, 0xffff0000, v50
    v_lshlrev_b32 v150, 16, v51
    v_and_b32 v151, 0xffff0000, v51
    v_lshlrev_b32 v152, 16, v52
    v_and_b32 v153, 0xffff0000, v52
    v_lshlrev_b32 v154, 16, v53
    v_and_b32 v155, 0xffff0000, v53
    v_lshlrev_b32 v156, 16, v54
    v_and_b32 v157, 0xffff0000, v54
    v_lshlrev_b32 v158, 16, v55
    v_and_b32 v159, 0xffff0000, v55
    v_lshlrev_b32 v160, 16, v56
    v_and_b32 v161, 0xffff0000, v56
    v_lshlrev_b32 v162, 16, v57
    v_and_b32 v163, 0xffff0000, v57
    v_lshlrev_b32 v164, 16, v58
    v_and_b32 v165, 0xffff0000, v58
    v_lshlrev_b32 v166, 16, v59
    v_and_b32 v167, 0xffff0000, v59
    v_pk_mul_f32 v[168:169], v[80:81], v[224:225]
    v_pk_fma_f32 v[168:169], v[88:89], v[216:217], v[168:169]
    v_pk_fma_f32 v[168:169], v[96:97], v[208:209], v[168:169]
    v_pk_fma_f32 v[168:169], v[104:105], v[200:201], v[168:169]
    v_pk_mul_f32 v[168:169], v[168:169], v[136:137]
    v_pk_mul_f32 v[176:177], v[88:89], v[224:225]
    v_pk_fma_f32 v[176:177], v[96:97], v[216:217], v[176:177]
    v_pk_fma_f32 v[176:177], v[104:105], v[208:209], v[176:177]
    v_pk_fma_f32 v[176:177], v[112:113], v[200:201], v[176:177]
    v_pk_mul_f32 v[176:177], v[176:177], v[144:145]
    v_pk_mul_f32 v[184:185], v[96:97], v[224:225]
    v_pk_fma_f32 v[184:185], v[104:105], v[216:217], v[184:185]
    v_pk_fma_f32 v[184:185], v[112:113], v[208:209], v[184:185]
    v_pk_fma_f32 v[184:185], v[120:121], v[200:201], v[184:185]
    v_pk_mul_f32 v[184:185], v[184:185], v[152:153]
    v_pk_mul_f32 v[192:193], v[104:105], v[224:225]
    v_pk_fma_f32 v[192:193], v[112:113], v[216:217], v[192:193]
    v_pk_fma_f32 v[192:193], v[120:121], v[208:209], v[192:193]
    v_pk_fma_f32 v[192:193], v[128:129], v[200:201], v[192:193]
    v_pk_mul_f32 v[192:193], v[192:193], v[160:161]
    v_cvt_pk_bf16_f32 v16, v192, v184
    v_cvt_pk_bf16_f32 v17, v176, v168
    ds_write_b64 v7, v[16:17] offset:0
    v_cvt_pk_bf16_f32 v18, v193, v185
    v_cvt_pk_bf16_f32 v19, v177, v169
    ds_write_b64 v7, v[18:19] offset:528
    v_pk_mul_f32 v[170:171], v[82:83], v[226:227]
    v_pk_fma_f32 v[170:171], v[90:91], v[218:219], v[170:171]
    v_pk_fma_f32 v[170:171], v[98:99], v[210:211], v[170:171]
    v_pk_fma_f32 v[170:171], v[106:107], v[202:203], v[170:171]
    v_pk_mul_f32 v[170:171], v[170:171], v[138:139]
    v_pk_mul_f32 v[178:179], v[90:91], v[226:227]
    v_pk_fma_f32 v[178:179], v[98:99], v[218:219], v[178:179]
    v_pk_fma_f32 v[178:179], v[106:107], v[210:211], v[178:179]
    v_pk_fma_f32 v[178:179], v[114:115], v[202:203], v[178:179]
    v_pk_mul_f32 v[178:179], v[178:179], v[146:147]
    v_pk_mul_f32 v[186:187], v[98:99], v[226:227]
    v_pk_fma_f32 v[186:187], v[106:107], v[218:219], v[186:187]
    v_pk_fma_f32 v[186:187], v[114:115], v[210:211], v[186:187]
    v_pk_fma_f32 v[186:187], v[122:123], v[202:203], v[186:187]
    v_pk_mul_f32 v[186:187], v[186:187], v[154:155]
    v_pk_mul_f32 v[194:195], v[106:107], v[226:227]
    v_pk_fma_f32 v[194:195], v[114:115], v[218:219], v[194:195]
    v_pk_fma_f32 v[194:195], v[122:123], v[210:211], v[194:195]
    v_pk_fma_f32 v[194:195], v[130:131], v[202:203], v[194:195]
    v_pk_mul_f32 v[194:195], v[194:195], v[162:163]
    v_cvt_pk_bf16_f32 v20, v194, v186
    v_cvt_pk_bf16_f32 v21, v178, v170
    ds_write_b64 v7, v[20:21] offset:1056
    v_cvt_pk_bf16_f32 v22, v195, v187
    v_cvt_pk_bf16_f32 v23, v179, v171
    ds_write_b64 v7, v[22:23] offset:1584
    v_pk_mul_f32 v[172:173], v[84:85], v[228:229]
    v_pk_fma_f32 v[172:173], v[92:93], v[220:221], v[172:173]
    v_pk_fma_f32 v[172:173], v[100:101], v[212:213], v[172:173]
    v_pk_fma_f32 v[172:173], v[108:109], v[204:205], v[172:173]
    v_pk_mul_f32 v[172:173], v[172:173], v[140:141]
    v_pk_mul_f32 v[180:181], v[92:93], v[228:229]
    v_pk_fma_f32 v[180:181], v[100:101], v[220:221], v[180:181]
    v_pk_fma_f32 v[180:181], v[108:109], v[212:213], v[180:181]
    v_pk_fma_f32 v[180:181], v[116:117], v[204:205], v[180:181]
    v_pk_mul_f32 v[180:181], v[180:181], v[148:149]
    v_pk_mul_f32 v[188:189], v[100:101], v[228:229]
    v_pk_fma_f32 v[188:189], v[108:109], v[220:221], v[188:189]
    v_pk_fma_f32 v[188:189], v[116:117], v[212:213], v[188:189]
    v_pk_fma_f32 v[188:189], v[124:125], v[204:205], v[188:189]
    v_pk_mul_f32 v[188:189], v[188:189], v[156:157]
    v_pk_mul_f32 v[196:197], v[108:109], v[228:229]
    v_pk_fma_f32 v[196:197], v[116:117], v[220:221], v[196:197]
    v_pk_fma_f32 v[196:197], v[124:125], v[212:213], v[196:197]
    v_pk_fma_f32 v[196:197], v[132:133], v[204:205], v[196:197]
    v_pk_mul_f32 v[196:197], v[196:197], v[164:165]
    v_cvt_pk_bf16_f32 v24, v196, v188
    v_cvt_pk_bf16_f32 v25, v180, v172
    ds_write_b64 v7, v[24:25] offset:2112
    v_cvt_pk_bf16_f32 v26, v197, v189
    v_cvt_pk_bf16_f32 v27, v181, v173
    ds_write_b64 v7, v[26:27] offset:2640
    v_pk_mul_f32 v[174:175], v[86:87], v[230:231]
    v_pk_fma_f32 v[174:175], v[94:95], v[222:223], v[174:175]
    v_pk_fma_f32 v[174:175], v[102:103], v[214:215], v[174:175]
    v_pk_fma_f32 v[174:175], v[110:111], v[206:207], v[174:175]
    v_pk_mul_f32 v[174:175], v[174:175], v[142:143]
    v_pk_mul_f32 v[182:183], v[94:95], v[230:231]
    v_pk_fma_f32 v[182:183], v[102:103], v[222:223], v[182:183]
    v_pk_fma_f32 v[182:183], v[110:111], v[214:215], v[182:183]
    v_pk_fma_f32 v[182:183], v[118:119], v[206:207], v[182:183]
    v_pk_mul_f32 v[182:183], v[182:183], v[150:151]
    v_pk_mul_f32 v[190:191], v[102:103], v[230:231]
    v_pk_fma_f32 v[190:191], v[110:111], v[222:223], v[190:191]
    v_pk_fma_f32 v[190:191], v[118:119], v[214:215], v[190:191]
    v_pk_fma_f32 v[190:191], v[126:127], v[206:207], v[190:191]
    v_pk_mul_f32 v[190:191], v[190:191], v[158:159]
    v_pk_mul_f32 v[198:199], v[110:111], v[230:231]
    v_pk_fma_f32 v[198:199], v[118:119], v[222:223], v[198:199]
    v_pk_fma_f32 v[198:199], v[126:127], v[214:215], v[198:199]
    v_pk_fma_f32 v[198:199], v[134:135], v[206:207], v[198:199]
    v_pk_mul_f32 v[198:199], v[198:199], v[166:167]
    v_cvt_pk_bf16_f32 v28, v198, v190
    v_cvt_pk_bf16_f32 v29, v182, v174
    ds_write_b64 v7, v[28:29] offset:3168
    v_cvt_pk_bf16_f32 v30, v199, v191
    v_cvt_pk_bf16_f32 v31, v183, v175
    ds_write_b64 v7, v[30:31] offset:3696
    s_waitcnt lgkmcnt(0)
    s_barrier
    ds_read_b128 v[16:19], v9 offset:0
    ds_read_b128 v[20:23], v9 offset:1056
    ds_read_b128 v[24:27], v9 offset:2112
    ds_read_b128 v[28:31], v9 offset:3168
    buffer_load_dword v78, off, s[84:87], 0 offset:16 sc1
    s_waitcnt lgkmcnt(3)
    buffer_store_dwordx4 v[16:19], v10, s[56:59], s3 offen sc1
    s_add_u32 s3, s3, 8192
    s_waitcnt lgkmcnt(2)
    buffer_store_dwordx4 v[20:23], v10, s[56:59], s3 offen sc1
    s_add_u32 s3, s3, 8192
    s_waitcnt lgkmcnt(1)
    buffer_store_dwordx4 v[24:27], v10, s[56:59], s3 offen sc1
    s_add_u32 s3, s3, 8192
    s_waitcnt lgkmcnt(0)
    buffer_store_dwordx4 v[28:31], v10, s[56:59], s3 offen sc1
    s_add_u32 s3, s3, 8192
    v_add_u32 v7, s70, v8
    s_waitcnt vmcnt(5)
    ds_write_b128 v7, v[232:235] offset:32
    v_alignbit_b32 v32, v233, v232, 16
    v_alignbit_b32 v33, v234, v233, 16
    v_alignbit_b32 v34, v235, v234, 16
    v_alignbit_b32 v35, v248, v235, 16
    ds_write_b128 v7, v[32:35] offset:4192
    ds_write_b128 v7, v[236:239] offset:1056
    v_alignbit_b32 v36, v237, v236, 16
    v_alignbit_b32 v37, v238, v237, 16
    v_alignbit_b32 v38, v239, v238, 16
    v_alignbit_b32 v39, v249, v239, 16
    ds_write_b128 v7, v[36:39] offset:5216
    ds_write_b128 v7, v[240:243] offset:2080
    v_alignbit_b32 v40, v241, v240, 16
    v_alignbit_b32 v41, v242, v241, 16
    v_alignbit_b32 v42, v243, v242, 16
    v_alignbit_b32 v43, v250, v243, 16
    ds_write_b128 v7, v[40:43] offset:6240
    ds_write_b128 v7, v[244:247] offset:3104
    v_alignbit_b32 v44, v245, v244, 16
    v_alignbit_b32 v45, v246, v245, 16
    v_alignbit_b32 v46, v247, v246, 16
    v_alignbit_b32 v47, v251, v247, 16
    ds_write_b128 v7, v[44:47] offset:7264
    v_lshlrev_b32 v12, 16, v232
    s_mov_b64 exec, 1
    ds_write_b32 v7, v12 offset:4188
    s_mov_b64 exec, -1
    s_waitcnt vmcnt(0)
    v_readfirstlane_b32 s82, v78
    s_nop 3
    s_cmp_ge_u32 s82, 1
    s_cbranch_scc1 sig_go8
    s_mov_b32 s84, s38
    s_and_b32 s85, s39, 0xffff
    s_mov_b32 s86, 256
    s_mov_b32 s87, 0x00020000
    v_mov_b32 v15, 16
    s_mov_b32 s80, 0
zp8:
    buffer_load_dword v14, v15, s[84:87], 0 offen sc1
    s_waitcnt vmcnt(0)
    v_readfirstlane_b32 s81, v14
    s_nop 3
    s_add_u32 s80, s80, 1
    s_cmp_ge_u32 s81, 1
    s_cbranch_scc1 zd8
    s_sleep 8
    s_cmp_lt_u32 s80, 0x40000
    s_cbranch_scc1 zp8
zd8:
    s_mov_b32 s82, 1
sig_go8:
    v_mov_b32 v13, 1
    s_waitcnt vmcnt(0)
    s_mov_b64 exec, 1
    buffer_store_byte v13, off, s[56:59], s4 sc1
    s_mov_b64 exec, -1
    s_lshl_b32 s63, s65, 16
    s_and_b32 s65, s65, 0xffff0000
    s_bitcmp1_b32 s68, 12
    s_cselect_b32 s65, s65, s63
    v_and_b32 v2, 15, v1
    v_lshrrev_b32 v3, 4, v1
    v_lshlrev_b32 v4, 1, v2
    v_lshlrev_b32 v5, 4, v3
    v_sub_u32 v4, v4, v5
    v_add_u32 v4, 18, v4
    v_and_b32 v5, 1, v2
    v_cmp_eq_u32 vcc, 0, v5
    v_mov_b32 v5, 0
    v_mov_b32 v6, 4158
    s_nop 1
    v_cndmask_b32 v5, v5, v6, vcc
    v_add_u32 v4, v4, v5
    v_add_u32 v200, s70, v4
    v_lshlrev_b32 v4, 5, v2
    v_lshl_add_u32 v4, v3, 4, v4
    v_sub_u32 v4, 496, v4
    v_add_u32 v201, s69, v4
    v_lshlrev_b32 v4, 5, v2
    v_lshl_add_u32 v4, v3, 3, v4
    v_sub_u32 v5, 504, v4
    v_add_u32 v5, s69, v5
    s_lshl_b32 s78, s66, 13
    s_bfe_u32 s63, s68, 0x6000c
    s_add_u32 s78, s78, s63
    s_add_u32 s78, s78, 9437312
    s_mov_b32 s79, 8
    s_mov_b32 s42, -1
    s_mov_b32 s77, 0
    s_mov_b32 s76, 1
    s_add_u32 s3, s68, 12582912
    s_waitcnt lgkmcnt(0)
    v_add_u32 v202, 32, v200
    v_add_u32 v203, 1056, v200
    v_add_u32 v204, 2080, v200
    v_add_u32 v205, 3104, v200
    ds_read2_b32 v[48:49], v202 offset0:0 offset1:1
    ds_read2_b32 v[50:51], v202 offset0:2 offset1:3
    ds_read2_b32 v[52:53], v202 offset0:128 offset1:129
    ds_read2_b32 v[54:55], v202 offset0:130 offset1:131
    ds_read2_b32 v[56:57], v203 offset0:0 offset1:1
    ds_read2_b32 v[58:59], v203 offset0:2 offset1:3
    ds_read2_b32 v[60:61], v203 offset0:128 offset1:129
    ds_read2_b32 v[62:63], v203 offset0:130 offset1:131
    ds_read2_b32 v[64:65], v204 offset0:0 offset1:1
    ds_read2_b32 v[66:67], v204 offset0:2 offset1:3
    ds_read2_b32 v[68:69], v204 offset0:128 offset1:129
    ds_read2_b32 v[70:71], v204 offset0:130 offset1:131
    ds_read2_b32 v[72:73], v205 offset0:0 offset1:1
    ds_read2_b32 v[74:75], v205 offset0:2 offset1:3
    ds_read2_b32 v[76:77], v205 offset0:128 offset1:129
    ds_read2_b32 v[78:79], v205 offset0:130 offset1:131
    s_cmp_lg_u32 s62, 7
    s_cbranch_scc1 k1c_kw
    s_mov_b32 s80, 0
poll9:
    buffer_load_ubyte v14, v1, s[56:59], s71 offen sc1
    s_waitcnt vmcnt(0)
    v_cmp_ne_u32 vcc, 0, v14
    s_add_u32 s80, s80, 1
    s_and_b32 s81, vcc_lo, s5
    s_cmp_eq_u32 s81, s5
    s_cbranch_scc1 polled9
    s_sleep 1
    s_cmp_lt_u32 s80, 0x40000
    s_cbranch_scc1 poll9
polled9:
    v_mov_b32 v14, 163328
    s_or_b32 s81, vcc_lo, s5
    v_mov_b32 v15, s81
    ds_write_b32 v14, v15 offset:8
    s_branch k1c_kd
k1c_kw:
    v_mov_b32 v14, 163328
    s_mov_b32 s80, 0
lw10:
    ds_read_b32 v15, v14 offset:8
    s_waitcnt lgkmcnt(0)
    v_readfirstlane_b32 s81, v15
    s_add_u32 s80, s80, 1
    s_nop 2
    s_and_b32 s81, s81, s5
    s_cmp_eq_u32 s81, s5
    s_cbranch_scc1 lwd10
    s_sleep 1
    s_cmp_lt_u32 s80, 0x1000000
    s_cbranch_scc1 lw10
lwd10:
k1c_kd:
    s_add_u32 m0, s69, 0
    buffer_load_dwordx4 v8, s[56:59], s3 offen lds
    s_add_u32 s3, s3, 1024
    s_add_u32 m0, s69, 1024
    buffer_load_dwordx4 v8, s[56:59], s3 offen lds
    s_add_u32 s3, s3, 1024
    s_add_u32 m0, s69, 2048
    buffer_load_dwordx4 v8, s[56:59], s3 offen lds
    s_add_u32 s3, s3, 1024
    s_add_u32 m0, s69, 3072
    buffer_load_dwordx4 v8, s[56:59], s3 offen lds
    s_add_u32 s3, s3, 1024
    s_waitcnt vmcnt(0)
    ds_read_b128 v[80:83], v201 offset:3616
    ds_read_b128 v[84:87], v201 offset:3104
    ds_read_b128 v[88:91], v201 offset:2592
    ds_read_b128 v[92:95], v201 offset:2080
    ds_read_b128 v[96:99], v201 offset:1568
    ds_read_b128 v[100:103], v201 offset:1056
    ds_read_b128 v[104:107], v201 offset:544
    ds_read_b128 v[108:111], v201 offset:32
    v_readfirstlane_b32 s81, v15
    s_lshr_b32 s4, s2, 5
    s_add_u32 s63, s62, s4
    s_and_b32 s63, s63, 7
    s_mul_i32 s63, s63, 22528
    s_mul_i32 s4, s4, 180224
    s_add_u32 s4, s4, s63
    s_add_u32 s4, s4, 10485760
    s_and_b32 s81, s81, 3
    s_cmp_eq_u32 s81, 3
    s_cselect_b32 s43, -1, 0
    s_cselect_b32 s44, -1, 0
    s_setprio 3
    s_waitcnt lgkmcnt(0)
    v_add_u32 v202, 96, v200
    v_add_u32 v203, 1120, v200
    v_add_u32 v204, 2144, v200
    v_add_u32 v205, 3168, v200
    v_mfma_f32_16x16x32_bf16 v[16:19], v[48:51], v[80:83], 0
    ds_read_b128 v[144:147], v201 offset:3680
    v_mfma_f32_16x16x32_bf16 v[20:23], v[52:55], v[80:83], 0
    ds_read2_b32 v[112:113], v202 offset0:0 offset1:1
    v_mfma_f32_16x16x32_bf16 v[24:27], v[56:59], v[80:83], 0
    ds_read2_b32 v[114:115], v202 offset0:2 offset1:3
    v_mfma_f32_16x16x32_bf16 v[28:31], v[60:63], v[80:83], 0
    ds_read2_b32 v[116:117], v202 offset0:128 offset1:129
    v_mfma_f32_16x16x32_bf16 v[32:35], v[64:67], v[80:83], 0
    ds_read2_b32 v[118:119], v202 offset0:130 offset1:131
    v_mfma_f32_16x16x32_bf16 v[36:39], v[68:71], v[80:83], 0
    ds_read2_b32 v[120:121], v203 offset0:0 offset1:1
    v_mfma_f32_16x16x32_bf16 v[40:43], v[72:75], v[80:83], 0
    ds_read2_b32 v[122:123], v203 offset0:2 offset1:3
    v_mfma_f32_16x16x32_bf16 v[44:47], v[76:79], v[80:83], 0
    ds_read2_b32 v[124:125], v203 offset0:128 offset1:129
    v_mfma_f32_16x16x32_bf16 v[20:23], v[48:51], v[84:87], v[20:23]
    ds_read2_b32 v[126:127], v203 offset0:130 offset1:131
    v_mfma_f32_16x16x32_bf16 v[24:27], v[52:55], v[84:87], v[24:27]
    ds_read2_b32 v[128:129], v204 offset0:0 offset1:1
    v_mfma_f32_16x16x32_bf16 v[28:31], v[56:59], v[84:87], v[28:31]
    ds_read2_b32 v[130:131], v204 offset0:2 offset1:3
    v_mfma_f32_16x16x32_bf16 v[32:35], v[60:63], v[84:87], v[32:35]
    ds_read2_b32 v[132:133], v204 offset0:128 offset1:129
    v_mfma_f32_16x16x32_bf16 v[36:39], v[64:67], v[84:87], v[36:39]
    ds_read2_b32 v[134:135], v204 offset0:130 offset1:131
    v_mfma_f32_16x16x32_bf16 v[40:43], v[68:71], v[84:87], v[40:43]
    ds_read2_b32 v[136:137], v205 offset0:0 offset1:1
    v_mfma_f32_16x16x32_bf16 v[44:47], v[72:75], v[84:87], v[44:47]
    ds_read2_b32 v[138:139], v205 offset0:2 offset1:3
    v_mfma_f32_16x16x32_bf16 v[24:27], v[48:51], v[88:91], v[24:27]
    ds_read2_b32 v[140:141], v205 offset0:128 offset1:129
    v_mfma_f32_16x16x32_bf16 v[28:31], v[52:55], v[88:91], v[28:31]
    ds_read2_b32 v[142:143], v205 offset0:130 offset1:131
    v_mfma_f32_16x16x32_bf16 v[32:35], v[56:59], v[88:91], v[32:35]
    ds_read_b128 v[148:151], v201 offset:3168
    v_mfma_f32_16x16x32_bf16 v[36:39], v[60:63], v[88:91], v[36:39]
    ds_read_b128 v[152:155], v201 offset:2656
    v_mfma_f32_16x16x32_bf16 v[40:43], v[64:67], v[88:91], v[40:43]
    ds_read_b128 v[156:159], v201 offset:2144
    v_mfma_f32_16x16x32_bf16 v[44:47], v[68:71], v[88:91], v[44:47]
    ds_read_b128 v[160:163], v201 offset:1632
    v_mfma_f32_16x16x32_bf16 v[28:31], v[48:51], v[92:95], v[28:31]
    ds_read_b128 v[164:167], v201 offset:1120
    v_mfma_f32_16x16x32_bf16 v[32:35], v[52:55], v[92:95], v[32:35]
    ds_read_b128 v[168:171], v201 offset:608
    v_mfma_f32_16x16x32_bf16 v[36:39], v[56:59], v[92:95], v[36:39]
    ds_read_b128 v[172:175], v201 offset:96
    v_mfma_f32_16x16x32_bf16 v[40:43], v[60:63], v[92:95], v[40:43]
    v_mfma_f32_16x16x32_bf16 v[44:47], v[64:67], v[92:95], v[44:47]
    v_mfma_f32_16x16x32_bf16 v[32:35], v[48:51], v[96:99], v[32:35]
    v_mfma_f32_16x16x32_bf16 v[36:39], v[52:55], v[96:99], v[36:39]
    v_mfma_f32_16x16x32_bf16 v[40:43], v[56:59], v[96:99], v[40:43]
    v_mfma_f32_16x16x32_bf16 v[44:47], v[60:63], v[96:99], v[44:47]
    v_mfma_f32_16x16x32_bf16 v[36:39], v[48:51], v[100:103], v[36:39]
    v_mfma_f32_16x16x32_bf16 v[40:43], v[52:55], v[100:103], v[40:43]
    v_mfma_f32_16x16x32_bf16 v[44:47], v[56:59], v[100:103], v[44:47]
    v_mfma_f32_16x16x32_bf16 v[40:43], v[48:51], v[104:107], v[40:43]
    v_mfma_f32_16x16x32_bf16 v[44:47], v[52:55], v[104:107], v[44:47]
    v_mfma_f32_16x16x32_bf16 v[44:47], v[48:51], v[108:111], v[44:47]
    s_waitcnt lgkmcnt(0)
    v_add_u32 v202, 160, v200
    v_add_u32 v203, 1184, v200
    v_add_u32 v204, 2208, v200
    v_add_u32 v205, 3232, v200
    v_mfma_f32_16x16x32_bf16 v[16:19], v[112:115], v[144:147], v[16:19]
    ds_read_b128 v[80:83], v201 offset:3744
    v_mfma_f32_16x16x32_bf16 v[20:23], v[116:119], v[144:147], v[20:23]
    ds_read2_b32 v[48:49], v202 offset0:0 offset1:1
    v_mfma_f32_16x16x32_bf16 v[24:27], v[120:123], v[144:147], v[24:27]
    ds_read2_b32 v[50:51], v202 offset0:2 offset1:3
    v_mfma_f32_16x16x32_bf16 v[28:31], v[124:127], v[144:147], v[28:31]
    ds_read2_b32 v[52:53], v202 offset0:128 offset1:129
    v_mfma_f32_16x16x32_bf16 v[32:35], v[128:131], v[144:147], v[32:35]
    ds_read2_b32 v[54:55], v202 offset0:130 offset1:131
    v_mfma_f32_16x16x32_bf16 v[36:39], v[132:135], v[144:147], v[36:39]
    ds_read2_b32 v[56:57], v203 offset0:0 offset1:1
    v_mfma_f32_16x16x32_bf16 v[40:43], v[136:139], v[144:147], v[40:43]
    ds_read2_b32 v[58:59], v203 offset0:2 offset1:3
    v_mfma_f32_16x16x32_bf16 v[44:47], v[140:143], v[144:147], v[44:47]
    ds_read2_b32 v[60:61], v203 offset0:128 offset1:129
    v_mfma_f32_16x16x32_bf16 v[20:23], v[112:115], v[148:151], v[20:23]
    ds_read2_b32 v[62:63], v203 offset0:130 offset1:131
    v_mfma_f32_16x16x32_bf16 v[24:27], v[116:119], v[148:151], v[24:27]
    ds_read2_b32 v[64:65], v204 offset0:0 offset1:1
    v_mfma_f32_16x16x32_bf16 v[28:31], v[120:123], v[148:151], v[28:31]
    ds_read2_b32 v[66:67], v204 offset0:2 offset1:3
    v_mfma_f32_16x16x32_bf16 v[32:35], v[124:127], v[148:151], v[32:35]
    ds_read2_b32 v[68:69], v204 offset0:128 offset1:129
    v_mfma_f32_16x16x32_bf16 v[36:39], v[128:131], v[148:151], v[36:39]
    ds_read2_b32 v[70:71], v204 offset0:130 offset1:131
    v_mfma_f32_16x16x32_bf16 v[40:43], v[132:135], v[148:151], v[40:43]
    ds_read2_b32 v[72:73], v205 offset0:0 offset1:1
    v_mfma_f32_16x16x32_bf16 v[44:47], v[136:139], v[148:151], v[44:47]
    ds_read2_b32 v[74:75], v205 offset0:2 offset1:3
    v_mfma_f32_16x16x32_bf16 v[24:27], v[112:115], v[152:155], v[24:27]
    ds_read2_b32 v[76:77], v205 offset0:128 offset1:129
    v_mfma_f32_16x16x32_bf16 v[28:31], v[116:119], v[152:155], v[28:31]
    ds_read2_b32 v[78:79], v205 offset0:130 offset1:131
    v_mfma_f32_16x16x32_bf16 v[32:35], v[120:123], v[152:155], v[32:35]
    ds_read_b128 v[84:87], v201 offset:3232
    v_mfma_f32_16x16x32_bf16 v[36:39], v[124:127], v[152:155], v[36:39]
    ds_read_b128 v[88:91], v201 offset:2720
    v_mfma_f32_16x16x32_bf16 v[40:43], v[128:131], v[152:155], v[40:43]
    ds_read_b128 v[92:95], v201 offset:2208
    v_mfma_f32_16x16x32_bf16 v[44:47], v[132:135], v[152:155], v[44:47]
    ds_read_b128 v[96:99], v201 offset:1696
    v_mfma_f32_16x16x32_bf16 v[28:31], v[112:115], v[156:159], v[28:31]
    ds_read_b128 v[100:103], v201 offset:1184
    v_mfma_f32_16x16x32_bf16 v[32:35], v[116:119], v[156:159], v[32:35]
    ds_read_b128 v[104:107], v201 offset:672
    v_mfma_f32_16x16x32_bf16 v[36:39], v[120:123], v[156:159], v[36:39]
    ds_read_b128 v[108:111], v201 offset:160
    v_mfma_f32_16x16x32_bf16 v[40:43], v[124:127], v[156:159], v[40:43]
    s_add_u32 s63, s4, 2048
    s_mov_b32 exec_lo, s43
    s_mov_b32 exec_hi, s43
    buffer_load_dwordx4 v[176:179], v8, s[56:59], s63 offen
    s_mov_b64 exec, -1
    v_mfma_f32_16x16x32_bf16 v[44:47], v[128:131], v[156:159], v[44:47]
    v_mfma_f32_16x16x32_bf16 v[32:35], v[112:115], v[160:163], v[32:35]
    s_add_u32 s63, s4, 3072
    s_mov_b32 exec_lo, s43
    s_mov_b32 exec_hi, s43
    buffer_load_dwordx4 v[180:183], v8, s[56:59], s63 offen
    s_mov_b64 exec, -1
    v_mfma_f32_16x16x32_bf16 v[36:39], v[116:119], v[160:163], v[36:39]
    v_mfma_f32_16x16x32_bf16 v[40:43], v[120:123], v[160:163], v[40:43]
    s_add_u32 s63, s4, 4096
    s_mov_b32 exec_lo, s43
    s_mov_b32 exec_hi, s43
    buffer_load_dwordx4 v[184:187], v8, s[56:59], s63 offen
    s_mov_b64 exec, -1
    v_mfma_f32_16x16x32_bf16 v[44:47], v[124:127], v[160:163], v[44:47]
    v_mfma_f32_16x16x32_bf16 v[36:39], v[112:115], v[164:167], v[36:39]
    v_mfma_f32_16x16x32_bf16 v[40:43], v[116:119], v[164:167], v[40:43]
    v_mfma_f32_16x16x32_bf16 v[44:47], v[120:123], v[164:167], v[44:47]
    v_mfma_f32_16x16x32_bf16 v[40:43], v[112:115], v[168:171], v[40:43]
    v_mfma_f32_16x16x32_bf16 v[44:47], v[116:119], v[168:171], v[44:47]
    v_mfma_f32_16x16x32_bf16 v[44:47], v[112:115], v[172:175], v[44:47]
    s_setprio 2
    s_waitcnt lgkmcnt(0)
    v_add_u32 v202, 224, v200
    v_add_u32 v203, 1248, v200
    v_add_u32 v204, 2272, v200
    v_add_u32 v205, 3296, v200
    v_mfma_f32_16x16x32_bf16 v[16:19], v[48:51], v[80:83], v[16:19]
    ds_read_b128 v[144:147], v201 offset:3808
    v_mfma_f32_16x16x32_bf16 v[20:23], v[52:55], v[80:83], v[20:23]
    ds_read2_b32 v[112:113], v202 offset0:0 offset1:1
    v_mfma_f32_16x16x32_bf16 v[24:27], v[56:59], v[80:83], v[24:27]
    ds_read2_b32 v[114:115], v202 offset0:2 offset1:3
    v_mfma_f32_16x16x32_bf16 v[28:31], v[60:63], v[80:83], v[28:31]
    ds_read2_b32 v[116:117], v202 offset0:128 offset1:129
    v_mfma_f32_16x16x32_bf16 v[32:35], v[64:67], v[80:83], v[32:35]
    ds_read2_b32 v[118:119], v202 offset0:130 offset1:131
    v_mfma_f32_16x16x32_bf16 v[36:39], v[68:71], v[80:83], v[36:39]
    ds_read2_b32 v[120:121], v203 offset0:0 offset1:1
    v_mfma_f32_16x16x32_bf16 v[40:43], v[72:75], v[80:83], v[40:43]
    ds_read2_b32 v[122:123], v203 offset0:2 offset1:3
    v_mfma_f32_16x16x32_bf16 v[44:47], v[76:79], v[80:83], v[44:47]
    ds_read2_b32 v[124:125], v203 offset0:128 offset1:129
    v_mfma_f32_16x16x32_bf16 v[20:23], v[48:51], v[84:87], v[20:23]
    ds_read2_b32 v[126:127], v203 offset0:130 offset1:131
    v_mfma_f32_16x16x32_bf16 v[24:27], v[52:55], v[84:87], v[24:27]
    ds_read2_b32 v[128:129], v204 offset0:0 offset1:1
    v_mfma_f32_16x16x32_bf16 v[28:31], v[56:59], v[84:87], v[28:31]
    ds_read2_b32 v[130:131], v204 offset0:2 offset1:3
    v_mfma_f32_16x16x32_bf16 v[32:35], v[60:63], v[84:87], v[32:35]
    ds_read2_b32 v[132:133], v204 offset0:128 offset1:129
    v_mfma_f32_16x16x32_bf16 v[36:39], v[64:67], v[84:87], v[36:39]
    ds_read2_b32 v[134:135], v204 offset0:130 offset1:131
    v_mfma_f32_16x16x32_bf16 v[40:43], v[68:71], v[84:87], v[40:43]
    ds_read2_b32 v[136:137], v205 offset0:0 offset1:1
    v_mfma_f32_16x16x32_bf16 v[44:47], v[72:75], v[84:87], v[44:47]
    ds_read2_b32 v[138:139], v205 offset0:2 offset1:3
    v_mfma_f32_16x16x32_bf16 v[24:27], v[48:51], v[88:91], v[24:27]
    ds_read2_b32 v[140:141], v205 offset0:128 offset1:129
    v_mfma_f32_16x16x32_bf16 v[28:31], v[52:55], v[88:91], v[28:31]
    ds_read2_b32 v[142:143], v205 offset0:130 offset1:131
    v_mfma_f32_16x16x32_bf16 v[32:35], v[56:59], v[88:91], v[32:35]
    ds_read_b128 v[148:151], v201 offset:3296
    v_mfma_f32_16x16x32_bf16 v[36:39], v[60:63], v[88:91], v[36:39]
    ds_read_b128 v[152:155], v201 offset:2784
    v_mfma_f32_16x16x32_bf16 v[40:43], v[64:67], v[88:91], v[40:43]
    ds_read_b128 v[156:159], v201 offset:2272
    v_mfma_f32_16x16x32_bf16 v[44:47], v[68:71], v[88:91], v[44:47]
    ds_read_b128 v[160:163], v201 offset:1760
    v_mfma_f32_16x16x32_bf16 v[28:31], v[48:51], v[92:95], v[28:31]
    ds_read_b128 v[164:167], v201 offset:1248
    v_mfma_f32_16x16x32_bf16 v[32:35], v[52:55], v[92:95], v[32:35]
    ds_read_b128 v[168:171], v201 offset:736
    v_mfma_f32_16x16x32_bf16 v[36:39], v[56:59], v[92:95], v[36:39]
    ds_read_b128 v[172:175], v201 offset:224
    v_mfma_f32_16x16x32_bf16 v[40:43], v[60:63], v[92:95], v[40:43]
    s_add_u32 s63, s4, 5120
    s_mov_b32 exec_lo, s43
    s_mov_b32 exec_hi, s43
    buffer_load_dwordx4 v[188:191], v8, s[56:59], s63 offen
    s_mov_b64 exec, -1
    v_mfma_f32_16x16x32_bf16 v[44:47], v[64:67], v[92:95], v[44:47]
    v_mfma_f32_16x16x32_bf16 v[32:35], v[48:51], v[96:99], v[32:35]
    s_add_u32 s63, s4, 6144
    s_mov_b32 exec_lo, s43
    s_mov_b32 exec_hi, s43
    buffer_load_dwordx4 v[192:195], v8, s[56:59], s63 offen
    s_mov_b64 exec, -1
    v_mfma_f32_16x16x32_bf16 v[36:39], v[52:55], v[96:99], v[36:39]
    v_mfma_f32_16x16x32_bf16 v[40:43], v[56:59], v[96:99], v[40:43]
    s_add_u32 s63, s4, 7168
    s_mov_b32 exec_lo, s43
    s_mov_b32 exec_hi, s43
    buffer_load_dwordx4 v[196:199], v8, s[56:59], s63 offen
    s_mov_b64 exec, -1
    v_mfma_f32_16x16x32_bf16 v[44:47], v[60:63], v[96:99], v[44:47]
    v_mfma_f32_16x16x32_bf16 v[36:39], v[48:51], v[100:103], v[36:39]
    v_mfma_f32_16x16x32_bf16 v[40:43], v[52:55], v[100:103], v[40:43]
    v_mfma_f32_16x16x32_bf16 v[44:47], v[56:59], v[100:103], v[44:47]
    v_mfma_f32_16x16x32_bf16 v[40:43], v[48:51], v[104:107], v[40:43]
    v_mfma_f32_16x16x32_bf16 v[44:47], v[52:55], v[104:107], v[44:47]
    v_mfma_f32_16x16x32_bf16 v[44:47], v[48:51], v[108:111], v[44:47]
    s_waitcnt lgkmcnt(0)
    v_add_u32 v202, 288, v200
    v_add_u32 v203, 1312, v200
    v_add_u32 v204, 2336, v200
    v_add_u32 v205, 3360, v200
    v_mfma_f32_16x16x32_bf16 v[16:19], v[112:115], v[144:147], v[16:19]
    ds_read_b128 v[80:83], v201 offset:3872
    v_mfma_f32_16x16x32_bf16 v[20:23], v[116:119], v[144:147], v[20:23]
    ds_read2_b32 v[48:49], v202 offset0:0 offset1:1
    v_mfma_f32_16x16x32_bf16 v[24:27], v[120:123], v[144:147], v[24:27]
    ds_read2_b32 v[50:51], v202 offset0:2 offset1:3
    v_mfma_f32_16x16x32_bf16 v[28:31], v[124:127], v[144:147], v[28:31]
    ds_read2_b32 v[52:53], v202 offset0:128 offset1:129
    v_mfma_f32_16x16x32_bf16 v[32:35], v[128:131], v[144:147], v[32:35]
    ds_read2_b32 v[54:55], v202 offset0:130 offset1:131
    v_mfma_f32_16x16x32_bf16 v[36:39], v[132:135], v[144:147], v[36:39]
    ds_read2_b32 v[56:57], v203 offset0:0 offset1:1
    v_mfma_f32_16x16x32_bf16 v[40:43], v[136:139], v[144:147], v[40:43]
    ds_read2_b32 v[58:59], v203 offset0:2 offset1:3
    v_mfma_f32_16x16x32_bf16 v[44:47], v[140:143], v[144:147], v[44:47]
    ds_read2_b32 v[60:61], v203 offset0:128 offset1:129
    v_mfma_f32_16x16x32_bf16 v[20:23], v[112:115], v[148:151], v[20:23]
    ds_read2_b32 v[62:63], v203 offset0:130 offset1:131
    v_mfma_f32_16x16x32_bf16 v[24:27], v[116:119], v[148:151], v[24:27]
    ds_read2_b32 v[64:65], v204 offset0:0 offset1:1
    v_mfma_f32_16x16x32_bf16 v[28:31], v[120:123], v[148:151], v[28:31]
    ds_read2_b32 v[66:67], v204 offset0:2 offset1:3
    v_mfma_f32_16x16x32_bf16 v[32:35], v[124:127], v[148:151], v[32:35]
    ds_read2_b32 v[68:69], v204 offset0:128 offset1:129
    v_mfma_f32_16x16x32_bf16 v[36:39], v[128:131], v[148:151], v[36:39]
    ds_read2_b32 v[70:71], v204 offset0:130 offset1:131
    v_mfma_f32_16x16x32_bf16 v[40:43], v[132:135], v[148:151], v[40:43]
    ds_read2_b32 v[72:73], v205 offset0:0 offset1:1
    v_mfma_f32_16x16x32_bf16 v[44:47], v[136:139], v[148:151], v[44:47]
    ds_read2_b32 v[74:75], v205 offset0:2 offset1:3
    v_mfma_f32_16x16x32_bf16 v[24:27], v[112:115], v[152:155], v[24:27]
    ds_read2_b32 v[76:77], v205 offset0:128 offset1:129
    v_mfma_f32_16x16x32_bf16 v[28:31], v[116:119], v[152:155], v[28:31]
    ds_read2_b32 v[78:79], v205 offset0:130 offset1:131
    v_mfma_f32_16x16x32_bf16 v[32:35], v[120:123], v[152:155], v[32:35]
    ds_read_b128 v[84:87], v201 offset:3360
    v_mfma_f32_16x16x32_bf16 v[36:39], v[124:127], v[152:155], v[36:39]
    ds_read_b128 v[88:91], v201 offset:2848
    v_mfma_f32_16x16x32_bf16 v[40:43], v[128:131], v[152:155], v[40:43]
    ds_read_b128 v[92:95], v201 offset:2336
    v_mfma_f32_16x16x32_bf16 v[44:47], v[132:135], v[152:155], v[44:47]
    ds_read_b128 v[96:99], v201 offset:1824
    v_mfma_f32_16x16x32_bf16 v[28:31], v[112:115], v[156:159], v[28:31]
    ds_read_b128 v[100:103], v201 offset:1312
    v_mfma_f32_16x16x32_bf16 v[32:35], v[116:119], v[156:159], v[32:35]
    ds_read_b128 v[104:107], v201 offset:800
    v_mfma_f32_16x16x32_bf16 v[36:39], v[120:123], v[156:159], v[36:39]
    ds_read_b128 v[108:111], v201 offset:288
    v_mfma_f32_16x16x32_bf16 v[40:43], v[124:127], v[156:159], v[40:43]
    s_add_u32 s63, s4, 10240
    s_mov_b32 exec_lo, s43
    s_mov_b32 exec_hi, s43
    buffer_load_dwordx4 v[208:211], v8, s[56:59], s63 offen
    s_mov_b64 exec, -1
    v_mfma_f32_16x16x32_bf16 v[44:47], v[128:131], v[156:159], v[44:47]
    v_mfma_f32_16x16x32_bf16 v[32:35], v[112:115], v[160:163], v[32:35]
    s_add_u32 s63, s4, 11264
    s_mov_b32 exec_lo, s43
    s_mov_b32 exec_hi, s43
    buffer_load_dwordx4 v[212:215], v8, s[56:59], s63 offen
    s_mov_b64 exec, -1
    v_mfma_f32_16x16x32_bf16 v[36:39], v[116:119], v[160:163], v[36:39]
    v_mfma_f32_16x16x32_bf16 v[40:43], v[120:123], v[160:163], v[40:43]
    s_add_u32 s63, s4, 12288
    s_mov_b32 exec_lo, s43
    s_mov_b32 exec_hi, s43
    buffer_load_dwordx4 v[216:219], v8, s[56:59], s63 offen
    s_mov_b64 exec, -1
    v_mfma_f32_16x16x32_bf16 v[44:47], v[124:127], v[160:163], v[44:47]
    v_mfma_f32_16x16x32_bf16 v[36:39], v[112:115], v[164:167], v[36:39]
    v_mfma_f32_16x16x32_bf16 v[40:43], v[116:119], v[164:167], v[40:43]
    v_mfma_f32_16x16x32_bf16 v[44:47], v[120:123], v[164:167], v[44:47]
    v_mfma_f32_16x16x32_bf16 v[40:43], v[112:115], v[168:171], v[40:43]
    v_mfma_f32_16x16x32_bf16 v[44:47], v[116:119], v[168:171], v[44:47]
    v_mfma_f32_16x16x32_bf16 v[44:47], v[112:115], v[172:175], v[44:47]
    s_setprio 1
    s_waitcnt lgkmcnt(0)
    v_add_u32 v202, 352, v200
    v_add_u32 v203, 1376, v200
    v_add_u32 v204, 2400, v200
    v_add_u32 v205, 3424, v200
    v_mfma_f32_16x16x32_bf16 v[16:19], v[48:51], v[80:83], v[16:19]
    ds_read_b128 v[144:147], v201 offset:3936
    v_mfma_f32_16x16x32_bf16 v[20:23], v[52:55], v[80:83], v[20:23]
    ds_read2_b32 v[112:113], v202 offset0:0 offset1:1
    v_mfma_f32_16x16x32_bf16 v[24:27], v[56:59], v[80:83], v[24:27]
    ds_read2_b32 v[114:115], v202 offset0:2 offset1:3
    v_mfma_f32_16x16x32_bf16 v[28:31], v[60:63], v[80:83], v[28:31]
    ds_read2_b32 v[116:117], v202 offset0:128 offset1:129
    v_mfma_f32_16x16x32_bf16 v[32:35], v[64:67], v[80:83], v[32:35]
    ds_read2_b32 v[118:119], v202 offset0:130 offset1:131
    v_mfma_f32_16x16x32_bf16 v[36:39], v[68:71], v[80:83], v[36:39]
    ds_read2_b32 v[120:121], v203 offset0:0 offset1:1
    v_mfma_f32_16x16x32_bf16 v[40:43], v[72:75], v[80:83], v[40:43]
    ds_read2_b32 v[122:123], v203 offset0:2 offset1:3
    v_mfma_f32_16x16x32_bf16 v[44:47], v[76:79], v[80:83], v[44:47]
    ds_read2_b32 v[124:125], v203 offset0:128 offset1:129
    v_mfma_f32_16x16x32_bf16 v[20:23], v[48:51], v[84:87], v[20:23]
    ds_read2_b32 v[126:127], v203 offset0:130 offset1:131
    v_mfma_f32_16x16x32_bf16 v[24:27], v[52:55], v[84:87], v[24:27]
    ds_read2_b32 v[128:129], v204 offset0:0 offset1:1
    v_mfma_f32_16x16x32_bf16 v[28:31], v[56:59], v[84:87], v[28:31]
    ds_read2_b32 v[130:131], v204 offset0:2 offset1:3
    v_mfma_f32_16x16x32_bf16 v[32:35], v[60:63], v[84:87], v[32:35]
    ds_read2_b32 v[132:133], v204 offset0:128 offset1:129
    v_mfma_f32_16x16x32_bf16 v[36:39], v[64:67], v[84:87], v[36:39]
    ds_read2_b32 v[134:135], v204 offset0:130 offset1:131
    v_mfma_f32_16x16x32_bf16 v[40:43], v[68:71], v[84:87], v[40:43]
    ds_read2_b32 v[136:137], v205 offset0:0 offset1:1
    v_mfma_f32_16x16x32_bf16 v[44:47], v[72:75], v[84:87], v[44:47]
    ds_read2_b32 v[138:139], v205 offset0:2 offset1:3
    v_mfma_f32_16x16x32_bf16 v[24:27], v[48:51], v[88:91], v[24:27]
    ds_read2_b32 v[140:141], v205 offset0:128 offset1:129
    v_mfma_f32_16x16x32_bf16 v[28:31], v[52:55], v[88:91], v[28:31]
    ds_read2_b32 v[142:143], v205 offset0:130 offset1:131
    v_mfma_f32_16x16x32_bf16 v[32:35], v[56:59], v[88:91], v[32:35]
    ds_read_b128 v[148:151], v201 offset:3424
    v_mfma_f32_16x16x32_bf16 v[36:39], v[60:63], v[88:91], v[36:39]
    ds_read_b128 v[152:155], v201 offset:2912
    v_mfma_f32_16x16x32_bf16 v[40:43], v[64:67], v[88:91], v[40:43]
    ds_read_b128 v[156:159], v201 offset:2400
    v_mfma_f32_16x16x32_bf16 v[44:47], v[68:71], v[88:91], v[44:47]
    ds_read_b128 v[160:163], v201 offset:1888
    v_mfma_f32_16x16x32_bf16 v[28:31], v[48:51], v[92:95], v[28:31]
    ds_read_b128 v[164:167], v201 offset:1376
    v_mfma_f32_16x16x32_bf16 v[32:35], v[52:55], v[92:95], v[32:35]
    ds_read_b128 v[168:171], v201 offset:864
    v_mfma_f32_16x16x32_bf16 v[36:39], v[56:59], v[92:95], v[36:39]
    ds_read_b128 v[172:175], v201 offset:352
    v_mfma_f32_16x16x32_bf16 v[40:43], v[60:63], v[92:95], v[40:43]
    s_add_u32 s63, s4, 13312
    s_mov_b32 exec_lo, s43
    s_mov_b32 exec_hi, s43
    buffer_load_dwordx4 v[220:223], v8, s[56:59], s63 offen
    s_mov_b64 exec, -1
    v_mfma_f32_16x16x32_bf16 v[44:47], v[64:67], v[92:95], v[44:47]
    v_mfma_f32_16x16x32_bf16 v[32:35], v[48:51], v[96:99], v[32:35]
    s_add_u32 s63, s4, 14336
    s_mov_b32 exec_lo, s43
    s_mov_b32 exec_hi, s43
    buffer_load_dwordx4 v[224:227], v8, s[56:59], s63 offen
    s_mov_b64 exec, -1
    v_mfma_f32_16x16x32_bf16 v[36:39], v[52:55], v[96:99], v[36:39]
    v_mfma_f32_16x16x32_bf16 v[40:43], v[56:59], v[96:99], v[40:43]
    s_add_u32 s63, s4, 15360
    s_mov_b32 exec_lo, s43
    s_mov_b32 exec_hi, s43
    buffer_load_dwordx4 v[228:231], v8, s[56:59], s63 offen
    s_mov_b64 exec, -1
    v_mfma_f32_16x16x32_bf16 v[44:47], v[60:63], v[96:99], v[44:47]
    v_mfma_f32_16x16x32_bf16 v[36:39], v[48:51], v[100:103], v[36:39]
    v_mfma_f32_16x16x32_bf16 v[40:43], v[52:55], v[100:103], v[40:43]
    v_mfma_f32_16x16x32_bf16 v[44:47], v[56:59], v[100:103], v[44:47]
    v_mfma_f32_16x16x32_bf16 v[40:43], v[48:51], v[104:107], v[40:43]
    v_mfma_f32_16x16x32_bf16 v[44:47], v[52:55], v[104:107], v[44:47]
    v_mfma_f32_16x16x32_bf16 v[44:47], v[48:51], v[108:111], v[44:47]
    s_waitcnt lgkmcnt(0)
    v_add_u32 v202, 416, v200
    v_add_u32 v203, 1440, v200
    v_add_u32 v204, 2464, v200
    v_add_u32 v205, 3488, v200
    v_mfma_f32_16x16x32_bf16 v[16:19], v[112:115], v[144:147], v[16:19]
    ds_read_b128 v[80:83], v201 offset:4000
    v_mfma_f32_16x16x32_bf16 v[20:23], v[116:119], v[144:147], v[20:23]
    ds_read2_b32 v[48:49], v202 offset0:0 offset1:1
    v_mfma_f32_16x16x32_bf16 v[24:27], v[120:123], v[144:147], v[24:27]
    ds_read2_b32 v[50:51], v202 offset0:2 offset1:3
    v_mfma_f32_16x16x32_bf16 v[28:31], v[124:127], v[144:147], v[28:31]
    ds_read2_b32 v[52:53], v202 offset0:128 offset1:129
    v_mfma_f32_16x16x32_bf16 v[32:35], v[128:131], v[144:147], v[32:35]
    ds_read2_b32 v[54:55], v202 offset0:130 offset1:131
    v_mfma_f32_16x16x32_bf16 v[36:39], v[132:135], v[144:147], v[36:39]
    ds_read2_b32 v[56:57], v203 offset0:0 offset1:1
    v_mfma_f32_16x16x32_bf16 v[40:43], v[136:139], v[144:147], v[40:43]
    ds_read2_b32 v[58:59], v203 offset0:2 offset1:3
    v_mfma_f32_16x16x32_bf16 v[44:47], v[140:143], v[144:147], v[44:47]
    ds_read2_b32 v[60:61], v203 offset0:128 offset1:129
    v_mfma_f32_16x16x32_bf16 v[20:23], v[112:115], v[148:151], v[20:23]
    ds_read2_b32 v[62:63], v203 offset0:130 offset1:131
    v_mfma_f32_16x16x32_bf16 v[24:27], v[116:119], v[148:151], v[24:27]
    ds_read2_b32 v[64:65], v204 offset0:0 offset1:1
    v_mfma_f32_16x16x32_bf16 v[28:31], v[120:123], v[148:151], v[28:31]
    ds_read2_b32 v[66:67], v204 offset0:2 offset1:3
    v_mfma_f32_16x16x32_bf16 v[32:35], v[124:127], v[148:151], v[32:35]
    ds_read2_b32 v[68:69], v204 offset0:128 offset1:129
    v_mfma_f32_16x16x32_bf16 v[36:39], v[128:131], v[148:151], v[36:39]
    ds_read2_b32 v[70:71], v204 offset0:130 offset1:131
    v_mfma_f32_16x16x32_bf16 v[40:43], v[132:135], v[148:151], v[40:43]
    ds_read2_b32 v[72:73], v205 offset0:0 offset1:1
    v_mfma_f32_16x16x32_bf16 v[44:47], v[136:139], v[148:151], v[44:47]
    ds_read2_b32 v[74:75], v205 offset0:2 offset1:3
    v_mfma_f32_16x16x32_bf16 v[24:27], v[112:115], v[152:155], v[24:27]
    ds_read2_b32 v[76:77], v205 offset0:128 offset1:129
    v_mfma_f32_16x16x32_bf16 v[28:31], v[116:119], v[152:155], v[28:31]
    ds_read2_b32 v[78:79], v205 offset0:130 offset1:131
    v_mfma_f32_16x16x32_bf16 v[32:35], v[120:123], v[152:155], v[32:35]
    ds_read_b128 v[84:87], v201 offset:3488
    v_mfma_f32_16x16x32_bf16 v[36:39], v[124:127], v[152:155], v[36:39]
    ds_read_b128 v[88:91], v201 offset:2976
    v_mfma_f32_16x16x32_bf16 v[40:43], v[128:131], v[152:155], v[40:43]
    ds_read_b128 v[92:95], v201 offset:2464
    v_mfma_f32_16x16x32_bf16 v[44:47], v[132:135], v[152:155], v[44:47]
    ds_read_b128 v[96:99], v201 offset:1952
    v_mfma_f32_16x16x32_bf16 v[28:31], v[112:115], v[156:159], v[28:31]
    ds_read_b128 v[100:103], v201 offset:1440
    v_mfma_f32_16x16x32_bf16 v[32:35], v[116:119], v[156:159], v[32:35]
    ds_read_b128 v[104:107], v201 offset:928
    v_mfma_f32_16x16x32_bf16 v[36:39], v[120:123], v[156:159], v[36:39]
    ds_read_b128 v[108:111], v201 offset:416
    v_mfma_f32_16x16x32_bf16 v[40:43], v[124:127], v[156:159], v[40:43]
    s_add_u32 s63, s4, 16384
    s_mov_b32 exec_lo, s43
    s_mov_b32 exec_hi, s43
    buffer_load_dwordx4 v[232:235], v8, s[56:59], s63 offen
    s_mov_b64 exec, -1
    v_mfma_f32_16x16x32_bf16 v[44:47], v[128:131], v[156:159], v[44:47]
    v_mfma_f32_16x16x32_bf16 v[32:35], v[112:115], v[160:163], v[32:35]
    s_add_u32 s63, s4, 17408
    s_mov_b32 exec_lo, s43
    s_mov_b32 exec_hi, s43
    buffer_load_dwordx4 v[236:239], v8, s[56:59], s63 offen
    s_mov_b64 exec, -1
    v_mfma_f32_16x16x32_bf16 v[36:39], v[116:119], v[160:163], v[36:39]
    v_mfma_f32_16x16x32_bf16 v[40:43], v[120:123], v[160:163], v[40:43]
    s_add_u32 s63, s4, 18432
    s_mov_b32 exec_lo, s43
    s_mov_b32 exec_hi, s43
    buffer_load_dwordx4 v[240:243], v8, s[56:59], s63 offen
    s_mov_b64 exec, -1
    v_mfma_f32_16x16x32_bf16 v[44:47], v[124:127], v[160:163], v[44:47]
    v_mfma_f32_16x16x32_bf16 v[36:39], v[112:115], v[164:167], v[36:39]
    v_mfma_f32_16x16x32_bf16 v[40:43], v[116:119], v[164:167], v[40:43]
    v_mfma_f32_16x16x32_bf16 v[44:47], v[120:123], v[164:167], v[44:47]
    v_mfma_f32_16x16x32_bf16 v[40:43], v[112:115], v[168:171], v[40:43]
    v_mfma_f32_16x16x32_bf16 v[44:47], v[116:119], v[168:171], v[44:47]
    v_mfma_f32_16x16x32_bf16 v[44:47], v[112:115], v[172:175], v[44:47]
    s_setprio 0
    s_waitcnt lgkmcnt(0)
    v_add_u32 v202, 480, v200
    v_add_u32 v203, 1504, v200
    v_add_u32 v204, 2528, v200
    v_add_u32 v205, 3552, v200
    v_mfma_f32_16x16x32_bf16 v[16:19], v[48:51], v[80:83], v[16:19]
    ds_read_b128 v[144:147], v201 offset:4064
    v_mfma_f32_16x16x32_bf16 v[20:23], v[52:55], v[80:83], v[20:23]
    ds_read2_b32 v[112:113], v202 offset0:0 offset1:1
    v_mfma_f32_16x16x32_bf16 v[24:27], v[56:59], v[80:83], v[24:27]
    ds_read2_b32 v[114:115], v202 offset0:2 offset1:3
    v_mfma_f32_16x16x32_bf16 v[28:31], v[60:63], v[80:83], v[28:31]
    ds_read2_b32 v[116:117], v202 offset0:128 offset1:129
    v_mfma_f32_16x16x32_bf16 v[32:35], v[64:67], v[80:83], v[32:35]
    ds_read2_b32 v[118:119], v202 offset0:130 offset1:131
    v_mfma_f32_16x16x32_bf16 v[36:39], v[68:71], v[80:83], v[36:39]
    ds_read2_b32 v[120:121], v203 offset0:0 offset1:1
    v_mfma_f32_16x16x32_bf16 v[40:43], v[72:75], v[80:83], v[40:43]
    ds_read2_b32 v[122:123], v203 offset0:2 offset1:3
    v_mfma_f32_16x16x32_bf16 v[44:47], v[76:79], v[80:83], v[44:47]
    ds_read2_b32 v[124:125], v203 offset0:128 offset1:129
    v_mfma_f32_16x16x32_bf16 v[20:23], v[48:51], v[84:87], v[20:23]
    ds_read2_b32 v[126:127], v203 offset0:130 offset1:131
    v_mfma_f32_16x16x32_bf16 v[24:27], v[52:55], v[84:87], v[24:27]
    ds_read2_b32 v[128:129], v204 offset0:0 offset1:1
    v_mfma_f32_16x16x32_bf16 v[28:31], v[56:59], v[84:87], v[28:31]
    ds_read2_b32 v[130:131], v204 offset0:2 offset1:3
    v_mfma_f32_16x16x32_bf16 v[32:35], v[60:63], v[84:87], v[32:35]
    ds_read2_b32 v[132:133], v204 offset0:128 offset1:129
    v_mfma_f32_16x16x32_bf16 v[36:39], v[64:67], v[84:87], v[36:39]
    ds_read2_b32 v[134:135], v204 offset0:130 offset1:131
    v_mfma_f32_16x16x32_bf16 v[40:43], v[68:71], v[84:87], v[40:43]
    ds_read2_b32 v[136:137], v205 offset0:0 offset1:1
    v_mfma_f32_16x16x32_bf16 v[44:47], v[72:75], v[84:87], v[44:47]
    ds_read2_b32 v[138:139], v205 offset0:2 offset1:3
    v_mfma_f32_16x16x32_bf16 v[24:27], v[48:51], v[88:91], v[24:27]
    ds_read2_b32 v[140:141], v205 offset0:128 offset1:129
    v_mfma_f32_16x16x32_bf16 v[28:31], v[52:55], v[88:91], v[28:31]
    ds_read2_b32 v[142:143], v205 offset0:130 offset1:131
    v_mfma_f32_16x16x32_bf16 v[32:35], v[56:59], v[88:91], v[32:35]
    ds_read_b128 v[148:151], v201 offset:3552
    v_mfma_f32_16x16x32_bf16 v[36:39], v[60:63], v[88:91], v[36:39]
    ds_read_b128 v[152:155], v201 offset:3040
    v_mfma_f32_16x16x32_bf16 v[40:43], v[64:67], v[88:91], v[40:43]
    ds_read_b128 v[156:159], v201 offset:2528
    v_mfma_f32_16x16x32_bf16 v[44:47], v[68:71], v[88:91], v[44:47]
    ds_read_b128 v[160:163], v201 offset:2016
    v_mfma_f32_16x16x32_bf16 v[28:31], v[48:51], v[92:95], v[28:31]
    ds_read_b128 v[164:167], v201 offset:1504
    v_mfma_f32_16x16x32_bf16 v[32:35], v[52:55], v[92:95], v[32:35]
    ds_read_b128 v[168:171], v201 offset:992
    v_mfma_f32_16x16x32_bf16 v[36:39], v[56:59], v[92:95], v[36:39]
    ds_read_b128 v[172:175], v201 offset:480
    v_mfma_f32_16x16x32_bf16 v[40:43], v[60:63], v[92:95], v[40:43]
    s_add_u32 s63, s4, 19456
    s_mov_b32 exec_lo, s43
    s_mov_b32 exec_hi, s43
    buffer_load_dwordx4 v[244:247], v8, s[56:59], s63 offen
    s_mov_b64 exec, -1
    v_mfma_f32_16x16x32_bf16 v[44:47], v[64:67], v[92:95], v[44:47]
    v_mfma_f32_16x16x32_bf16 v[32:35], v[48:51], v[96:99], v[32:35]
    s_add_u32 s63, s4, 20480
    s_mov_b32 exec_lo, s43
    s_mov_b32 exec_hi, s43
    buffer_load_dwordx4 v[248:251], v8, s[56:59], s63 offen
    s_mov_b64 exec, -1
    v_mfma_f32_16x16x32_bf16 v[36:39], v[52:55], v[96:99], v[36:39]
    v_mfma_f32_16x16x32_bf16 v[40:43], v[56:59], v[96:99], v[40:43]
    s_add_u32 s63, s4, 21504
    s_mov_b32 exec_lo, s43
    s_mov_b32 exec_hi, s43
    buffer_load_dwordx4 v[252:255], v8, s[56:59], s63 offen
    s_mov_b64 exec, -1
    v_mfma_f32_16x16x32_bf16 v[44:47], v[60:63], v[96:99], v[44:47]
    v_mfma_f32_16x16x32_bf16 v[36:39], v[48:51], v[100:103], v[36:39]
    v_mfma_f32_16x16x32_bf16 v[40:43], v[52:55], v[100:103], v[40:43]
    v_mfma_f32_16x16x32_bf16 v[44:47], v[56:59], v[100:103], v[44:47]
    v_mfma_f32_16x16x32_bf16 v[40:43], v[48:51], v[104:107], v[40:43]
    v_mfma_f32_16x16x32_bf16 v[44:47], v[52:55], v[104:107], v[44:47]
    v_mfma_f32_16x16x32_bf16 v[44:47], v[48:51], v[108:111], v[44:47]
    s_waitcnt lgkmcnt(0)
    v_mfma_f32_16x16x32_bf16 v[16:19], v[112:115], v[144:147], v[16:19]
    ds_read_b64 v[80:81], v5 offset:3584
    v_mfma_f32_16x16x32_bf16 v[20:23], v[116:119], v[144:147], v[20:23]
    ds_read_b64 v[82:83], v5 offset:3072
    v_mfma_f32_16x16x32_bf16 v[24:27], v[120:123], v[144:147], v[24:27]
    ds_read_b64 v[84:85], v5 offset:2560
    v_mfma_f32_16x16x32_bf16 v[28:31], v[124:127], v[144:147], v[28:31]
    ds_read_b64 v[86:87], v5 offset:2048
    v_mfma_f32_16x16x32_bf16 v[32:35], v[128:131], v[144:147], v[32:35]
    ds_read_b64 v[88:89], v5 offset:1536
    v_mfma_f32_16x16x32_bf16 v[36:39], v[132:135], v[144:147], v[36:39]
    ds_read_b64 v[90:91], v5 offset:1024
    v_mfma_f32_16x16x32_bf16 v[40:43], v[136:139], v[144:147], v[40:43]
    ds_read_b64 v[92:93], v5 offset:512
    v_mfma_f32_16x16x32_bf16 v[44:47], v[140:143], v[144:147], v[44:47]
    ds_read_b64 v[94:95], v5 offset:0
    v_mfma_f32_16x16x32_bf16 v[20:23], v[112:115], v[148:151], v[20:23]
    v_mfma_f32_16x16x32_bf16 v[24:27], v[116:119], v[148:151], v[24:27]
    v_mfma_f32_16x16x32_bf16 v[28:31], v[120:123], v[148:151], v[28:31]
    v_mfma_f32_16x16x32_bf16 v[32:35], v[124:127], v[148:151], v[32:35]
    s_waitcnt lgkmcnt(0)
    v_mfma_f32_16x16x32_bf16 v[36:39], v[128:131], v[148:151], v[36:39]
    v_and_b32 v48, 0xffff0000, v81
    v_lshlrev_b32 v49, 16, v81
    v_and_b32 v50, 0xffff0000, v80
    v_lshlrev_b32 v51, 16, v80
    v_mfma_f32_16x16x32_bf16 v[40:43], v[132:135], v[148:151], v[40:43]
    v_mul_f32 v48, s65, v48
    v_mul_f32 v49, s65, v49
    v_mul_f32 v50, s65, v50
    v_mul_f32 v51, s65, v51
    v_mfma_f32_16x16x32_bf16 v[44:47], v[136:139], v[148:151], v[44:47]
    v_cvt_pk_bf16_f32 v48, 0, v48
    v_cvt_pk_bf16_f32 v49, 0, v49
    v_cvt_pk_bf16_f32 v50, 0, v50
    v_cvt_pk_bf16_f32 v51, 0, v51
    v_mfma_f32_16x16x32_bf16 v[24:27], v[112:115], v[152:155], v[24:27]
    v_and_b32 v52, 0xffff0000, v83
    v_lshlrev_b32 v53, 16, v83
    v_and_b32 v54, 0xffff0000, v82
    v_lshlrev_b32 v55, 16, v82
    v_mfma_f32_16x16x32_bf16 v[28:31], v[116:119], v[152:155], v[28:31]
    v_mul_f32 v52, s65, v52
    v_mul_f32 v53, s65, v53
    v_mul_f32 v54, s65, v54
    v_mul_f32 v55, s65, v55
    v_mfma_f32_16x16x32_bf16 v[32:35], v[120:123], v[152:155], v[32:35]
    v_cvt_pk_bf16_f32 v52, 0, v52
    v_cvt_pk_bf16_f32 v53, 0, v53
    v_cvt_pk_bf16_f32 v54, 0, v54
    v_cvt_pk_bf16_f32 v55, 0, v55
    v_mfma_f32_16x16x32_bf16 v[36:39], v[124:127], v[152:155], v[36:39]
    v_and_b32 v56, 0xffff0000, v85
    v_lshlrev_b32 v57, 16, v85
    v_and_b32 v58, 0xffff0000, v84
    v_lshlrev_b32 v59, 16, v84
    v_mfma_f32_16x16x32_bf16 v[40:43], v[128:131], v[152:155], v[40:43]
    v_mul_f32 v56, s65, v56
    v_mul_f32 v57, s65, v57
    v_mul_f32 v58, s65, v58
    v_mul_f32 v59, s65, v59
    v_mfma_f32_16x16x32_bf16 v[44:47], v[132:135], v[152:155], v[44:47]
    v_cvt_pk_bf16_f32 v56, 0, v56
    v_cvt_pk_bf16_f32 v57, 0, v57
    v_cvt_pk_bf16_f32 v58, 0, v58
    v_cvt_pk_bf16_f32 v59, 0, v59
    v_mfma_f32_16x16x32_bf16 v[28:31], v[112:115], v[156:159], v[28:31]
    v_and_b32 v60, 0xffff0000, v87
    v_lshlrev_b32 v61, 16, v87
    v_and_b32 v62, 0xffff0000, v86
    v_lshlrev_b32 v63, 16, v86
    v_mfma_f32_16x16x32_bf16 v[32:35], v[116:119], v[156:159], v[32:35]
    v_mul_f32 v60, s65, v60
    v_mul_f32 v61, s65, v61
    v_mul_f32 v62, s65, v62
    v_mul_f32 v63, s65, v63
    v_mfma_f32_16x16x32_bf16 v[36:39], v[120:123], v[156:159], v[36:39]
    v_cvt_pk_bf16_f32 v60, 0, v60
    v_cvt_pk_bf16_f32 v61, 0, v61
    v_cvt_pk_bf16_f32 v62, 0, v62
    v_cvt_pk_bf16_f32 v63, 0, v63
    v_mfma_f32_16x16x32_bf16 v[40:43], v[124:127], v[156:159], v[40:43]
    v_and_b32 v64, 0xffff0000, v89
    v_lshlrev_b32 v65, 16, v89
    v_and_b32 v66, 0xffff0000, v88
    v_lshlrev_b32 v67, 16, v88
    v_mfma_f32_16x16x32_bf16 v[44:47], v[128:131], v[156:159], v[44:47]
    v_mul_f32 v64, s65, v64
    v_mul_f32 v65, s65, v65
    v_mul_f32 v66, s65, v66
    v_mul_f32 v67, s65, v67
    v_mfma_f32_16x16x32_bf16 v[32:35], v[112:115], v[160:163], v[32:35]
    v_cvt_pk_bf16_f32 v64, 0, v64
    v_cvt_pk_bf16_f32 v65, 0, v65
    v_cvt_pk_bf16_f32 v66, 0, v66
    v_cvt_pk_bf16_f32 v67, 0, v67
    v_mfma_f32_16x16x32_bf16 v[36:39], v[116:119], v[160:163], v[36:39]
    v_and_b32 v68, 0xffff0000, v91
    v_lshlrev_b32 v69, 16, v91
    v_and_b32 v70, 0xffff0000, v90
    v_lshlrev_b32 v71, 16, v90
    v_mfma_f32_16x16x32_bf16 v[40:43], v[120:123], v[160:163], v[40:43]
    v_mul_f32 v68, s65, v68
    v_mul_f32 v69, s65, v69
    v_mul_f32 v70, s65, v70
    v_mul_f32 v71, s65, v71
    v_mfma_f32_16x16x32_bf16 v[44:47], v[124:127], v[160:163], v[44:47]
    v_cvt_pk_bf16_f32 v68, 0, v68
    v_cvt_pk_bf16_f32 v69, 0, v69
    v_cvt_pk_bf16_f32 v70, 0, v70
    v_cvt_pk_bf16_f32 v71, 0, v71
    v_mfma_f32_16x16x32_bf16 v[36:39], v[112:115], v[164:167], v[36:39]
    v_and_b32 v72, 0xffff0000, v93
    v_lshlrev_b32 v73, 16, v93
    v_and_b32 v74, 0xffff0000, v92
    v_lshlrev_b32 v75, 16, v92
    v_mfma_f32_16x16x32_bf16 v[40:43], v[116:119], v[164:167], v[40:43]
    v_mul_f32 v72, s65, v72
    v_mul_f32 v73, s65, v73
    v_mul_f32 v74, s65, v74
    v_mul_f32 v75, s65, v75
    v_mfma_f32_16x16x32_bf16 v[44:47], v[120:123], v[164:167], v[44:47]
    v_cvt_pk_bf16_f32 v72, 0, v72
    v_cvt_pk_bf16_f32 v73, 0, v73
    v_cvt_pk_bf16_f32 v74, 0, v74
    v_cvt_pk_bf16_f32 v75, 0, v75
    v_mfma_f32_16x16x32_bf16 v[40:43], v[112:115], v[168:171], v[40:43]
    v_and_b32 v76, 0xffff0000, v95
    v_lshlrev_b32 v77, 16, v95
    v_and_b32 v78, 0xffff0000, v94
    v_lshlrev_b32 v79, 16, v94
    v_mfma_f32_16x16x32_bf16 v[44:47], v[116:119], v[168:171], v[44:47]
    v_mul_f32 v76, s65, v76
    v_mul_f32 v77, s65, v77
    v_mul_f32 v78, s65, v78
    v_mul_f32 v79, s65, v79
    v_mfma_f32_16x16x32_bf16 v[44:47], v[112:115], v[172:175], v[44:47]
    v_cvt_pk_bf16_f32 v76, 0, v76
    v_cvt_pk_bf16_f32 v77, 0, v77
    v_cvt_pk_bf16_f32 v78, 0, v78
    v_cvt_pk_bf16_f32 v79, 0, v79
    s_add_u32 s3, s68, 6291456
    v_cvt_pk_bf16_f32 v16, 0, v16
    v_cvt_pk_bf16_f32 v17, 0, v17
    v_cvt_pk_bf16_f32 v18, 0, v18
    v_cvt_pk_bf16_f32 v19, 0, v19
    v_add_f32 v16, v16, v48
    v_add_f32 v17, v17, v49
    v_add_f32 v18, v18, v50
    v_add_f32 v19, v19, v51
    v_cvt_pk_bf16_f32 v16, v16, v17
    v_cvt_pk_bf16_f32 v17, v18, v19
    buffer_store_dwordx2 v[16:17], v4, s[56:59], s3 offen offset:0 sc1
    v_cvt_pk_bf16_f32 v20, 0, v20
    v_cvt_pk_bf16_f32 v21, 0, v21
    v_cvt_pk_bf16_f32 v22, 0, v22
    v_cvt_pk_bf16_f32 v23, 0, v23
    v_add_f32 v20, v20, v52
    v_add_f32 v21, v21, v53
    v_add_f32 v22, v22, v54
    v_add_f32 v23, v23, v55
    v_cvt_pk_bf16_f32 v20, v20, v21
    v_cvt_pk_bf16_f32 v21, v22, v23
    buffer_store_dwordx2 v[20:21], v4, s[56:59], s3 offen offset:512 sc1
    v_cvt_pk_bf16_f32 v24, 0, v24
    v_cvt_pk_bf16_f32 v25, 0, v25
    v_cvt_pk_bf16_f32 v26, 0, v26
    v_cvt_pk_bf16_f32 v27, 0, v27
    v_add_f32 v24, v24, v56
    v_add_f32 v25, v25, v57
    v_add_f32 v26, v26, v58
    v_add_f32 v27, v27, v59
    v_cvt_pk_bf16_f32 v24, v24, v25
    v_cvt_pk_bf16_f32 v25, v26, v27
    buffer_store_dwordx2 v[24:25], v4, s[56:59], s3 offen offset:1024 sc1
    v_cvt_pk_bf16_f32 v28, 0, v28
    v_cvt_pk_bf16_f32 v29, 0, v29
    v_cvt_pk_bf16_f32 v30, 0, v30
    v_cvt_pk_bf16_f32 v31, 0, v31
    v_add_f32 v28, v28, v60
    v_add_f32 v29, v29, v61
    v_add_f32 v30, v30, v62
    v_add_f32 v31, v31, v63
    v_cvt_pk_bf16_f32 v28, v28, v29
    v_cvt_pk_bf16_f32 v29, v30, v31
    buffer_store_dwordx2 v[28:29], v4, s[56:59], s3 offen offset:1536 sc1
    v_cvt_pk_bf16_f32 v32, 0, v32
    v_cvt_pk_bf16_f32 v33, 0, v33
    v_cvt_pk_bf16_f32 v34, 0, v34
    v_cvt_pk_bf16_f32 v35, 0, v35
    v_add_f32 v32, v32, v64
    v_add_f32 v33, v33, v65
    v_add_f32 v34, v34, v66
    v_add_f32 v35, v35, v67
    v_cvt_pk_bf16_f32 v32, v32, v33
    v_cvt_pk_bf16_f32 v33, v34, v35
    buffer_store_dwordx2 v[32:33], v4, s[56:59], s3 offen offset:2048 sc1
    v_cvt_pk_bf16_f32 v36, 0, v36
    v_cvt_pk_bf16_f32 v37, 0, v37
    v_cvt_pk_bf16_f32 v38, 0, v38
    v_cvt_pk_bf16_f32 v39, 0, v39
    v_add_f32 v36, v36, v68
    v_add_f32 v37, v37, v69
    v_add_f32 v38, v38, v70
    v_add_f32 v39, v39, v71
    v_cvt_pk_bf16_f32 v36, v36, v37
    v_cvt_pk_bf16_f32 v37, v38, v39
    buffer_store_dwordx2 v[36:37], v4, s[56:59], s3 offen offset:2560 sc1
    v_cvt_pk_bf16_f32 v40, 0, v40
    v_cvt_pk_bf16_f32 v41, 0, v41
    v_cvt_pk_bf16_f32 v42, 0, v42
    v_cvt_pk_bf16_f32 v43, 0, v43
    v_add_f32 v40, v40, v72
    v_add_f32 v41, v41, v73
    v_add_f32 v42, v42, v74
    v_add_f32 v43, v43, v75
    v_cvt_pk_bf16_f32 v40, v40, v41
    v_cvt_pk_bf16_f32 v41, v42, v43
    buffer_store_dwordx2 v[40:41], v4, s[56:59], s3 offen offset:3072 sc1
    s_nop 3
    v_cvt_pk_bf16_f32 v44, 0, v44
    v_cvt_pk_bf16_f32 v45, 0, v45
    v_cvt_pk_bf16_f32 v46, 0, v46
    v_cvt_pk_bf16_f32 v47, 0, v47
    v_add_f32 v44, v44, v76
    v_add_f32 v45, v45, v77
    v_add_f32 v46, v46, v78
    v_add_f32 v47, v47, v79
    v_cvt_pk_bf16_f32 v44, v44, v45
    v_cvt_pk_bf16_f32 v45, v46, v47
    buffer_store_dwordx2 v[44:45], v4, s[56:59], s3 offen offset:3584 sc1
    v_mov_b32 v14, 163328
    ds_read_b32 v15, v14 offset:4
    s_mov_b32 s75, 0
    s_waitcnt lgkmcnt(0)
    v_readfirstlane_b32 s81, v15
    s_nop 3
    s_and_b32 s81, s81, s43
    s_and_b32 s81, s81, 54525951
    s_cmp_eq_u32 s81, 54525951
    s_cbranch_scc0 k1c_ndf
    s_add_u32 s63, s4, 0
    s_mov_b32 exec_lo, s43
    s_mov_b32 exec_hi, s43
    buffer_load_dwordx4 v[168:171], v8, s[56:59], s63 offen
    s_mov_b64 exec, -1
    s_add_u32 s63, s4, 1024
    s_mov_b32 exec_lo, s43
    s_mov_b32 exec_hi, s43
    buffer_load_dwordx4 v[172:175], v8, s[56:59], s63 offen
    s_mov_b64 exec, -1
    s_add_u32 s63, s4, 8192
    s_mov_b32 exec_lo, s43
    s_mov_b32 exec_hi, s43
    buffer_load_dwordx4 v[200:203], v8, s[56:59], s63 offen
    s_mov_b64 exec, -1
    s_add_u32 s63, s4, 9216
    s_mov_b32 exec_lo, s43
    s_mov_b32 exec_hi, s43
    buffer_load_dwordx4 v[204:207], v8, s[56:59], s63 offen
    s_mov_b64 exec, -1
    s_mov_b32 s75, -1
    s_mov_b32 s42, 0
    s_branch k1c_df
k1c_ndf:
    s_sub_u32 s64, s71, 64
    v_mov_b32 v6, 0
    s_bitcmp1_b32 129, s62
    s_cselect_b64 exec, -1, 0
    buffer_load_ubyte v6, v1, s[56:59], s64 offen sc1
    s_add_u32 s63, s4, 0
    s_mov_b32 exec_lo, s43
    s_mov_b32 exec_hi, s43
    buffer_load_dwordx4 v[168:171], v8, s[56:59], s63 offen
    s_mov_b64 exec, -1
    s_add_u32 s63, s4, 1024
    s_mov_b32 exec_lo, s43
    s_mov_b32 exec_hi, s43
    buffer_load_dwordx4 v[172:175], v8, s[56:59], s63 offen
    s_mov_b64 exec, -1
    s_add_u32 s63, s4, 8192
    s_mov_b32 exec_lo, s43
    s_mov_b32 exec_hi, s43
    buffer_load_dwordx4 v[200:203], v8, s[56:59], s63 offen
    s_mov_b64 exec, -1
    s_add_u32 s63, s4, 9216
    s_mov_b32 exec_lo, s43
    s_mov_b32 exec_hi, s43
    buffer_load_dwordx4 v[204:207], v8, s[56:59], s63 offen
    s_mov_b64 exec, -1
    v_lshlrev_b32 v12, s79, v1
    v_mov_b32 v13, 1
    s_waitcnt vmcnt(5)
    s_mov_b32 exec_hi, 0
    buffer_store_byte v13, v12, s[56:59], s78 offen sc1
    s_mov_b64 exec, -1
    s_mov_b32 s42, 0
    s_waitcnt vmcnt(5)
    v_cmp_ne_u32 vcc, 0, v6
    v_mov_b32 v14, 163328
    s_mov_b32 s81, vcc_lo
    v_mov_b32 v15, s81
    s_mov_b64 exec, 1
    ds_or_b32 v14, v15 offset:4
    s_mov_b64 exec, -1
k1c_df:
    v_mov_b32 v14, 163328
    v_mov_b32 v15, 1
    s_mov_b64 exec, 1
    ds_add_u32 v14, v15
    s_mov_b64 exec, -1
    s_setprio 0
    s_cmp_lg_u32 s44, 0
    s_cbranch_scc1 g2_unit
    s_mov_b32 s5, 3
    s_mov_b32 s80, 0
poll11:
    buffer_load_ubyte v14, v1, s[56:59], s71 offen sc1
    s_waitcnt vmcnt(0)
    v_cmp_ne_u32 vcc, 0, v14
    s_add_u32 s80, s80, 1
    s_and_b32 s81, vcc_lo, s5
    s_cmp_eq_u32 s81, s5
    s_cbranch_scc1 polled11
    s_sleep 1
    s_cmp_lt_u32 s80, 0x40000
    s_cbranch_scc1 poll11
polled11:
    s_branch g2_unit
g2_unit:
    s_lshr_b32 s61, s2, 5
    s_mul_i32 s67, s61, 180224
    s_add_u32 s65, s62, s61
    s_and_b32 s65, s65, 7
    s_mul_i32 s63, s65, 22528
    s_add_u32 s67, s67, s63
    s_add_u32 s67, s67, 10485760
    v_lshlrev_b32 v2, 4, v1
    s_lshl_b32 s69, s2, 8
    s_add_u32 s69, s69, 9437184
    s_add_u32 s73, s69, 128
    s_and_b32 s60, s2, 7
    s_lshl_b32 s60, s60, 2
    s_bfe_u32 s63, s2, 0x20003
    s_add_u32 s60, s60, s63
    s_mov_b32 s70, 1
    s_mov_b32 s71, 0
    s_cmp_eq_u32 s76, 0
    s_cbranch_scc1 g2_nounit
    s_cmp_eq_u32 s43, -1
    s_cbranch_scc1 g2_bd
    v_lshlrev_b32 v12, s79, v1
    v_mov_b32 v13, 1
    s_waitcnt vmcnt(0)
    s_mov_b32 exec_lo, s42
    s_mov_b32 exec_hi, 0
    buffer_store_byte v13, v12, s[56:59], s78 offen sc1
    s_mov_b64 exec, -1
    s_mov_b32 s42, 0
    s_cmp_eq_u32 s43, 0
    s_cbranch_scc1 g2_loop
    s_mov_b32 s80, 0
poll12:
    buffer_load_ubyte v14, v1, s[56:59], s69 offen sc1
    s_waitcnt vmcnt(0)
    v_cmp_ne_u32 vcc, 0, v14
    s_add_u32 s80, s80, 1
    s_and_b32 s81, vcc_lo, s43
    s_cmp_eq_u32 s81, s43
    s_cbranch_scc1 polled12
    s_sleep 1
    s_cmp_lt_u32 s80, 0x40000
    s_cbranch_scc1 poll12
polled12:
g2_loop:
    buffer_load_dwordx4 v[168:171], v2, s[56:59], s67 offen offset:0
    buffer_load_dwordx4 v[172:175], v2, s[56:59], s67 offen offset:1024
    buffer_load_dwordx4 v[176:179], v2, s[56:59], s67 offen offset:2048
    buffer_load_dwordx4 v[180:183], v2, s[56:59], s67 offen offset:3072
    s_add_u32 s67, s67, 4096
    buffer_load_dwordx4 v[184:187], v2, s[56:59], s67 offen offset:0
    buffer_load_dwordx4 v[188:191], v2, s[56:59], s67 offen offset:1024
    buffer_load_dwordx4 v[192:195], v2, s[56:59], s67 offen offset:2048
    buffer_load_dwordx4 v[196:199], v2, s[56:59], s67 offen offset:3072
    s_add_u32 s67, s67, 4096
    buffer_load_dwordx4 v[200:203], v2, s[56:59], s67 offen offset:0
    buffer_load_dwordx4 v[204:207], v2, s[56:59], s67 offen offset:1024
    buffer_load_dwordx4 v[208:211], v2, s[56:59], s67 offen offset:2048
    buffer_load_dwordx4 v[212:215], v2, s[56:59], s67 offen offset:3072
    s_add_u32 s67, s67, 4096
    buffer_load_dwordx4 v[216:219], v2, s[56:59], s67 offen offset:0
    buffer_load_dwordx4 v[220:223], v2, s[56:59], s67 offen offset:1024
    buffer_load_dwordx4 v[224:227], v2, s[56:59], s67 offen offset:2048
    buffer_load_dwordx4 v[228:231], v2, s[56:59], s67 offen offset:3072
    s_add_u32 s67, s67, 4096
    buffer_load_dwordx4 v[232:235], v2, s[56:59], s67 offen offset:0
    buffer_load_dwordx4 v[236:239], v2, s[56:59], s67 offen offset:1024
    buffer_load_dwordx4 v[240:243], v2, s[56:59], s67 offen offset:2048
    buffer_load_dwordx4 v[244:247], v2, s[56:59], s67 offen offset:3072
    s_add_u32 s67, s67, 4096
    buffer_load_dwordx4 v[248:251], v2, s[56:59], s67 offen offset:0
    buffer_load_dwordx4 v[252:255], v2, s[56:59], s67 offen offset:1024
    s_cmp_eq_u32 s70, 0
    s_cbranch_scc1 g2_l2
g2_bd_ret:
    s_mov_b32 s44, s16
    s_and_b32 s45, s17, 0xffff
    s_mov_b32 s46, 2097152
    s_mov_b32 s47, 0x00020000
    s_mov_b32 s48, s36
    s_and_b32 s49, s37, 0xffff
    s_mov_b32 s50, 2097152
    s_mov_b32 s51, 0x00020000
    s_lshl_b32 s72, s60, 3
    s_add_u32 s72, s72, s62
    s_lshl_b32 s74, s72, 4
    s_lshl_b32 s63, s61, 18
    s_add_u32 s74, s74, s63
    s_add_u32 s74, s74, 6291456
    s_lshl_b32 s72, s72, 13
    s_lshl_b32 s63, s61, 7
    s_add_u32 s72, s72, s63
    s_add_u32 s63, s72, 4096
    v_lshlrev_b32 v3, 1, v1
    v_mov_b32 v4, 0
    v_mov_b32 v5, 0
    v_mov_b32 v6, 0
    v_mov_b32 v7, 0
    v_mov_b32 v8, 0
    v_mov_b32 v9, 0
    v_mov_b32 v10, 0
    v_mov_b32 v11, 0
    v_mov_b32 v16, 0
    v_mov_b32 v17, 0
    v_mov_b32 v18, 0
    v_mov_b32 v19, 0
    v_mov_b32 v20, 0
    v_mov_b32 v21, 0
    v_mov_b32 v22, 0
    v_mov_b32 v23, 0
    v_mov_b32 v24, 0
    v_mov_b32 v25, 0
    v_mov_b32 v26, 0
    v_mov_b32 v27, 0
    v_mov_b32 v28, 0
    v_mov_b32 v29, 0
    v_mov_b32 v30, 0
    v_mov_b32 v31, 0
    v_mov_b32 v32, 0
    v_mov_b32 v33, 0
    v_mov_b32 v34, 0
    v_mov_b32 v35, 0
    v_mov_b32 v36, 0
    v_mov_b32 v37, 0
    v_mov_b32 v38, 0
    v_mov_b32 v39, 0
    v_mov_b32 v40, 0
    v_mov_b32 v41, 0
    v_mov_b32 v42, 0
    v_mov_b32 v43, 0
    v_mov_b32 v44, 0
    v_mov_b32 v45, 0
    v_mov_b32 v46, 0
    v_mov_b32 v47, 0
    v_mov_b32 v48, 0
    v_mov_b32 v49, 0
    v_mov_b32 v50, 0
    v_mov_b32 v51, 0
    v_mov_b32 v52, 0
    v_mov_b32 v53, 0
    v_mov_b32 v54, 0
    v_mov_b32 v55, 0
    v_mov_b32 v56, 0
    v_mov_b32 v57, 0
    v_mov_b32 v58, 0
    v_mov_b32 v59, 0
    v_mov_b32 v60, 0
    v_mov_b32 v61, 0
    v_mov_b32 v62, 0
    v_mov_b32 v63, 0
    v_mov_b32 v64, 0
    v_mov_b32 v65, 0
    v_mov_b32 v66, 0
    v_mov_b32 v67, 0
    v_mov_b32 v68, 0
    v_mov_b32 v69, 0
    v_mov_b32 v70, 0
    v_mov_b32 v71, 0
    v_mov_b32 v72, 0
    v_mov_b32 v73, 0
    v_mov_b32 v74, 0
    v_mov_b32 v75, 0
    v_mov_b32 v76, 0
    v_mov_b32 v77, 0
    v_mov_b32 v78, 0
    v_mov_b32 v79, 0
g2_l2:
    s_mul_i32 s63, s65, 11
    s_add_u32 s64, s63, 10
    s_lshr_b32 s64, s64, 2
    s_lshl_b32 s68, 2, s64
    s_lshr_b32 s64, s63, 2
    s_lshl_b32 s64, 1, s64
    s_sub_u32 s68, s68, s64
    s_or_b32 s68, s68, 50331648
    s_mul_i32 s66, s60, 180224
    s_lshl_b32 s63, s63, 10
    s_add_u32 s66, s66, s63
    s_add_u32 s64, s66, 90112
    s_cmp_eq_u32 s62, 7
    s_cbranch_scc1 g2_pol
    v_mov_b32 v14, 163328
    s_mov_b32 s80, 0
lw13:
    ds_read_b32 v15, v14 offset:4
    s_waitcnt lgkmcnt(0)
    v_readfirstlane_b32 s81, v15
    s_add_u32 s80, s80, 1
    s_nop 2
    s_and_b32 s81, s81, s68
    s_cmp_eq_u32 s81, s68
    s_cbranch_scc1 lwd13
    s_sleep 1
    s_cmp_lt_u32 s80, 0x1000000
    s_cbranch_scc1 lw13
lwd13:
g2_pol_ret:
    buffer_load_dwordx4 v[80:83], v2, s[56:59], s66 offen offset:0
    buffer_load_dwordx4 v[84:87], v2, s[56:59], s64 offen offset:0
    buffer_load_dwordx4 v[88:91], v2, s[56:59], s66 offen offset:1024
    buffer_load_dwordx4 v[92:95], v2, s[56:59], s64 offen offset:1024
    buffer_load_dwordx4 v[96:99], v2, s[56:59], s66 offen offset:2048
    buffer_load_dwordx4 v[100:103], v2, s[56:59], s64 offen offset:2048
    buffer_load_dwordx4 v[104:107], v2, s[56:59], s66 offen offset:3072
    buffer_load_dwordx4 v[108:111], v2, s[56:59], s64 offen offset:3072
    s_add_u32 s66, s66, 4096
    s_add_u32 s64, s64, 4096
    buffer_load_dwordx4 v[112:115], v2, s[56:59], s66 offen offset:0
    buffer_load_dwordx4 v[116:119], v2, s[56:59], s64 offen offset:0
    s_waitcnt vmcnt(9)
    v_lshlrev_b32 v12, s79, v1
    v_mov_b32 v13, 1
    s_mov_b32 exec_lo, s75
    s_mov_b32 exec_hi, 0
    buffer_store_byte v13, v12, s[56:59], s78 offen sc1
    s_mov_b64 exec, -1
    buffer_load_dwordx4 v[120:123], v2, s[56:59], s66 offen offset:1024
    v_mfma_f32_32x32x16_bf16 v[16:31], v[80:83], v[168:171], v[16:31]
    v_mfma_f32_32x32x16_bf16 v[32:47], v[80:83], v[172:175], v[32:47]
    s_waitcnt vmcnt(10)
    buffer_load_dwordx4 v[124:127], v2, s[56:59], s64 offen offset:1024
    v_mfma_f32_32x32x16_bf16 v[48:63], v[84:87], v[168:171], v[48:63]
    v_mfma_f32_32x32x16_bf16 v[64:79], v[84:87], v[172:175], v[64:79]
    s_waitcnt vmcnt(10)
    buffer_load_dwordx4 v[128:131], v2, s[56:59], s66 offen offset:2048
    s_add_u32 s63, s72, 4096
    buffer_load_short_d16_hi v4, v3, s[44:47], s72 offen offset:0
    buffer_load_short_d16_hi v5, v3, s[44:47], s72 offen offset:1024
    buffer_load_short_d16_hi v6, v3, s[44:47], s72 offen offset:2048
    buffer_load_short_d16_hi v7, v3, s[44:47], s72 offen offset:3072
    buffer_load_short_d16_hi v8, v3, s[44:47], s63 offen offset:0
    buffer_load_short_d16_hi v9, v3, s[44:47], s63 offen offset:1024
    buffer_load_short_d16_hi v10, v3, s[44:47], s63 offen offset:2048
    buffer_load_short_d16_hi v11, v3, s[44:47], s63 offen offset:3072
    v_mfma_f32_32x32x16_bf16 v[16:31], v[88:91], v[176:179], v[16:31]
    v_mfma_f32_32x32x16_bf16 v[32:47], v[88:91], v[180:183], v[32:47]
    s_waitcnt vmcnt(18)
    buffer_load_dwordx4 v[132:135], v2, s[56:59], s64 offen offset:2048
    v_mfma_f32_32x32x16_bf16 v[48:63], v[92:95], v[176:179], v[48:63]
    v_mfma_f32_32x32x16_bf16 v[64:79], v[92:95], v[180:183], v[64:79]
    s_waitcnt vmcnt(18)
    buffer_load_dwordx4 v[136:139], v2, s[56:59], s66 offen offset:3072
    v_mfma_f32_32x32x16_bf16 v[16:31], v[96:99], v[184:187], v[16:31]
    v_mfma_f32_32x32x16_bf16 v[32:47], v[96:99], v[188:191], v[32:47]
    s_waitcnt vmcnt(18)
    buffer_load_dwordx4 v[140:143], v2, s[56:59], s64 offen offset:3072
    s_add_u32 s66, s66, 4096
    s_add_u32 s64, s64, 4096
    v_mfma_f32_32x32x16_bf16 v[48:63], v[100:103], v[184:187], v[48:63]
    v_mfma_f32_32x32x16_bf16 v[64:79], v[100:103], v[188:191], v[64:79]
    s_waitcnt vmcnt(18)
    buffer_load_dwordx4 v[144:147], v2, s[56:59], s66 offen offset:0
    v_mfma_f32_32x32x16_bf16 v[16:31], v[104:107], v[192:195], v[16:31]
    v_mfma_f32_32x32x16_bf16 v[32:47], v[104:107], v[196:199], v[32:47]
    s_waitcnt vmcnt(18)
    buffer_load_dwordx4 v[148:151], v2, s[56:59], s64 offen offset:0
    s_cmp_eq_u32 s62, 7
    s_cselect_b64 exec, -1, 0
    buffer_load_ubyte v12, v1, s[56:59], s73 offen sc1
    s_mov_b64 exec, -1
    v_mfma_f32_32x32x16_bf16 v[48:63], v[108:111], v[192:195], v[48:63]
    v_mfma_f32_32x32x16_bf16 v[64:79], v[108:111], v[196:199], v[64:79]
    s_waitcnt vmcnt(19)
    buffer_load_dwordx4 v[152:155], v2, s[56:59], s66 offen offset:1024
    v_mfma_f32_32x32x16_bf16 v[16:31], v[112:115], v[200:203], v[16:31]
    v_mfma_f32_32x32x16_bf16 v[32:47], v[112:115], v[204:207], v[32:47]
    s_waitcnt vmcnt(19)
    buffer_load_dwordx4 v[156:159], v2, s[56:59], s64 offen offset:1024
    v_mfma_f32_32x32x16_bf16 v[48:63], v[116:119], v[200:203], v[48:63]
    v_mfma_f32_32x32x16_bf16 v[64:79], v[116:119], v[204:207], v[64:79]
    s_waitcnt vmcnt(18)
    buffer_load_dwordx4 v[160:163], v2, s[56:59], s66 offen offset:2048
    v_mfma_f32_32x32x16_bf16 v[16:31], v[120:123], v[208:211], v[16:31]
    v_mfma_f32_32x32x16_bf16 v[32:47], v[120:123], v[212:215], v[32:47]
    s_waitcnt vmcnt(18)
    buffer_load_dwordx4 v[164:167], v2, s[56:59], s64 offen offset:2048
    v_mfma_f32_32x32x16_bf16 v[48:63], v[124:127], v[208:211], v[48:63]
    v_mfma_f32_32x32x16_bf16 v[64:79], v[124:127], v[212:215], v[64:79]
    s_waitcnt vmcnt(18)
    v_mfma_f32_32x32x16_bf16 v[16:31], v[128:131], v[216:219], v[16:31]
    v_mfma_f32_32x32x16_bf16 v[32:47], v[128:131], v[220:223], v[32:47]
    s_waitcnt vmcnt(9)
    v_mfma_f32_32x32x16_bf16 v[48:63], v[132:135], v[216:219], v[48:63]
    v_mfma_f32_32x32x16_bf16 v[64:79], v[132:135], v[220:223], v[64:79]
    s_waitcnt vmcnt(8)
    v_mfma_f32_32x32x16_bf16 v[16:31], v[136:139], v[224:227], v[16:31]
    v_mfma_f32_32x32x16_bf16 v[32:47], v[136:139], v[228:231], v[32:47]
    s_waitcnt vmcnt(7)
    v_mfma_f32_32x32x16_bf16 v[48:63], v[140:143], v[224:227], v[48:63]
    v_mfma_f32_32x32x16_bf16 v[64:79], v[140:143], v[228:231], v[64:79]
    s_waitcnt vmcnt(6)
    v_mfma_f32_32x32x16_bf16 v[16:31], v[144:147], v[232:235], v[16:31]
    v_mfma_f32_32x32x16_bf16 v[32:47], v[144:147], v[236:239], v[32:47]
    s_waitcnt vmcnt(5)
    v_mfma_f32_32x32x16_bf16 v[48:63], v[148:151], v[232:235], v[48:63]
    v_mfma_f32_32x32x16_bf16 v[64:79], v[148:151], v[236:239], v[64:79]
    v_mov_b32 v13, 163328
    ds_read_b64 v[14:15], v13
    s_cmp_eq_u32 s65, 7
    s_cbranch_scc1 g2_mfd
    s_waitcnt vmcnt(3)
    v_mfma_f32_32x32x16_bf16 v[16:31], v[152:155], v[240:243], v[16:31]
    v_mfma_f32_32x32x16_bf16 v[32:47], v[152:155], v[244:247], v[32:47]
    s_waitcnt vmcnt(2)
    v_mfma_f32_32x32x16_bf16 v[48:63], v[156:159], v[240:243], v[48:63]
    v_mfma_f32_32x32x16_bf16 v[64:79], v[156:159], v[244:247], v[64:79]
    s_waitcnt vmcnt(1)
    v_mfma_f32_32x32x16_bf16 v[16:31], v[160:163], v[248:251], v[16:31]
    v_mfma_f32_32x32x16_bf16 v[32:47], v[160:163], v[252:255], v[32:47]
    s_waitcnt vmcnt(0)
    v_mfma_f32_32x32x16_bf16 v[48:63], v[164:167], v[248:251], v[48:63]
    v_mfma_f32_32x32x16_bf16 v[64:79], v[164:167], v[252:255], v[64:79]
g2_mfd:
    s_sub_u32 s76, s76, 1
    s_cmp_eq_u32 s76, 0
    s_cbranch_scc1 g2_ud
    s_add_u32 s65, s65, 4
    s_add_u32 s67, s67, 69632
    s_mov_b32 s70, 0
    s_nop 7
    s_branch g2_loop
g2_ud:
    s_cmp_lg_u32 s62, 7
    s_cbranch_scc1 g2_np
    s_waitcnt vmcnt(0) lgkmcnt(0)
    v_cmp_ne_u32 vcc, 0, v12
    s_cmp_eq_u64 vcc, -1
    s_cbranch_scc0 g2_np
    v_mov_b32 v15, -1
    v_mov_b32 v13, 163328
    ds_write_b32 v13, v15 offset:4
g2_np:
    v_and_b32 v12, 15, v1
    v_lshrrev_b32 v13, 5, v1
    v_xor_b32 v12, v12, v13
    v_lshlrev_b32 v12, 4, v12
    v_and_b32 v13, 31, v1
    v_lshl_add_u32 v12, v13, 8, v12
    s_lshl_b32 s63, s62, 14
    v_add_u32 v12, s63, v12
    v_xor_b32 v169, 32, v12
    v_xor_b32 v170, 64, v12
    v_xor_b32 v171, 96, v12
    v_xor_b32 v172, 128, v12
    v_xor_b32 v173, 160, v12
    v_xor_b32 v174, 192, v12
    v_xor_b32 v175, 224, v12
    s_waitcnt vmcnt(0) lgkmcnt(0)
    s_lshr_b32 s63, s72, 13
    s_lshl_b32 s63, s63, 6
    s_add_u32 s63, s63, 8388608
    buffer_load_dwordx4 v[84:87], off, s[56:59], s63 offset:0
    buffer_load_dwordx4 v[88:91], off, s[56:59], s63 offset:16
    buffer_load_dwordx4 v[92:95], off, s[56:59], s63 offset:32
    buffer_load_dwordx4 v[96:99], off, s[56:59], s63 offset:48
    v_readfirstlane_b32 s63, v14
    v_readfirstlane_b32 s64, v15
    s_nop 3
    s_cmp_ge_i32 s63, 4
    s_cbranch_scc0 g2_cnt
g2_cnt_ret:
    s_bitcmp1_b32 s64, 31
    s_cbranch_scc0 g2_noy
    s_mov_b32 s71, 1
    v_lshlrev_b32 v14, 12, v1
    buffer_load_dwordx4 v[80:83], v14, s[56:59], s74 offen
g2_noy:
    ds_write_b128 v12, v[16:19] offset:0
    ds_write_b128 v12, v[32:35] offset:8192
    ds_write_b128 v169, v[20:23] offset:0
    ds_write_b128 v169, v[36:39] offset:8192
    ds_write_b128 v170, v[24:27] offset:0
    ds_write_b128 v170, v[40:43] offset:8192
    ds_write_b128 v171, v[28:31] offset:0
    ds_write_b128 v171, v[44:47] offset:8192
    ds_write_b128 v172, v[48:51] offset:0
    ds_write_b128 v172, v[64:67] offset:8192
    ds_write_b128 v173, v[52:55] offset:0
    ds_write_b128 v173, v[68:71] offset:8192
    ds_write_b128 v174, v[56:59] offset:0
    ds_write_b128 v174, v[72:75] offset:8192
    ds_write_b128 v175, v[60:63] offset:0
    ds_write_b128 v175, v[76:79] offset:8192
g2_bar:
    v_and_b32 v12, 15, v1
    s_lshl_b32 s63, s62, 1
    v_xor_b32 v12, s63, v12
    v_lshlrev_b32 v12, 4, v12
    v_lshl_add_u32 v12, v1, 8, v12
    v_xor_b32 v13, 16, v12
    v_add_u32 v14, 0x10000, v12
    v_add_u32 v15, 0x10000, v13
    s_waitcnt lgkmcnt(0)
    s_barrier
    v_mov_b32 v2, 163328
    ds_read_b32 v2, v2 offset:4
    ds_read_b128 v[16:19], v12 offset:0
    ds_read_b128 v[20:23], v13 offset:0
    ds_read_b128 v[24:27], v12 offset:16384
    ds_read_b128 v[28:31], v13 offset:16384
    ds_read_b128 v[32:35], v12 offset:32768
    ds_read_b128 v[36:39], v13 offset:32768
    ds_read_b128 v[40:43], v12 offset:49152
    ds_read_b128 v[44:47], v13 offset:49152
    s_waitcnt lgkmcnt(8)
    v_readfirstlane_b32 s64, v2
    v_lshlrev_b32 v2, 12, v1
    s_nop 2
    s_lshr_b32 s64, s64, 31
    s_cmp_gt_u32 s64, s71
    s_cbranch_scc0 g2_y2n
    s_mov_b32 s71, 1
    buffer_load_dwordx4 v[80:83], v2, s[56:59], s74 offen
g2_y2n:
    s_cmp_lg_u32 s77, 0
    s_cbranch_scc1 g2_s4
    ds_read_b128 v[48:51], v14 offset:0
    ds_read_b128 v[52:55], v15 offset:0
    ds_read_b128 v[56:59], v14 offset:16384
    ds_read_b128 v[60:63], v15 offset:16384
    ds_read_b128 v[64:67], v14 offset:32768
    ds_read_b128 v[68:71], v15 offset:32768
    ds_read_b128 v[72:75], v14 offset:49152
    ds_read_b128 v[76:79], v15 offset:49152
    s_waitcnt lgkmcnt(6)
    v_pk_add_f32 v[16:17], v[16:17], v[48:49]
    v_pk_add_f32 v[18:19], v[18:19], v[50:51]
    v_pk_add_f32 v[20:21], v[20:21], v[52:53]
    v_pk_add_f32 v[22:23], v[22:23], v[54:55]
    s_waitcnt lgkmcnt(4)
    v_pk_add_f32 v[24:25], v[24:25], v[56:57]
    v_pk_add_f32 v[26:27], v[26:27], v[58:59]
    v_pk_add_f32 v[28:29], v[28:29], v[60:61]
    v_pk_add_f32 v[30:31], v[30:31], v[62:63]
    s_waitcnt lgkmcnt(2)
    v_pk_add_f32 v[32:33], v[32:33], v[64:65]
    v_pk_add_f32 v[34:35], v[34:35], v[66:67]
    v_pk_add_f32 v[36:37], v[36:37], v[68:69]
    v_pk_add_f32 v[38:39], v[38:39], v[70:71]
    s_waitcnt lgkmcnt(0)
    v_pk_add_f32 v[40:41], v[40:41], v[72:73]
    v_pk_add_f32 v[42:43], v[42:43], v[74:75]
    v_pk_add_f32 v[44:45], v[44:45], v[76:77]
    v_pk_add_f32 v[46:47], v[46:47], v[78:79]
g2_s4:
    s_waitcnt lgkmcnt(0)
    v_pk_add_f32 v[16:17], v[16:17], v[24:25]
    v_pk_add_f32 v[18:19], v[18:19], v[26:27]
    v_pk_add_f32 v[20:21], v[20:21], v[28:29]
    v_pk_add_f32 v[22:23], v[22:23], v[30:31]
    v_pk_add_f32 v[32:33], v[32:33], v[40:41]
    v_pk_add_f32 v[34:35], v[34:35], v[42:43]
    v_pk_add_f32 v[36:37], v[36:37], v[44:45]
    v_pk_add_f32 v[38:39], v[38:39], v[46:47]
    v_pk_add_f32 v[16:17], v[16:17], v[32:33]
    v_pk_add_f32 v[18:19], v[18:19], v[34:35]
    v_pk_add_f32 v[20:21], v[20:21], v[36:37]
    v_pk_add_f32 v[22:23], v[22:23], v[38:39]
    v_cvt_pk_bf16_f32 v16, 0, v16
    v_cvt_pk_bf16_f32 v17, 0, v17
    v_cvt_pk_bf16_f32 v18, 0, v18
    v_cvt_pk_bf16_f32 v19, 0, v19
    v_cvt_pk_bf16_f32 v20, 0, v20
    v_cvt_pk_bf16_f32 v21, 0, v21
    v_cvt_pk_bf16_f32 v22, 0, v22
    v_cvt_pk_bf16_f32 v23, 0, v23
    s_cmp_lg_u32 s71, 0
    s_cbranch_scc1 g2_ydone
    s_cmp_eq_u32 s62, 7
    s_cbranch_scc1 g2_yp0
    s_mov_b32 s68, 0x80000000
    v_mov_b32 v14, 163328
    s_mov_b32 s80, 0
lw14:
    ds_read_b32 v15, v14 offset:4
    s_waitcnt lgkmcnt(0)
    v_readfirstlane_b32 s81, v15
    s_add_u32 s80, s80, 1
    s_nop 2
    s_and_b32 s81, s81, s68
    s_cmp_eq_u32 s81, s68
    s_cbranch_scc1 lwd14
    s_sleep 1
    s_cmp_lt_u32 s80, 0x1000000
    s_cbranch_scc1 lw14
lwd14:
    s_branch g2_ypd2
g2_yp0:
    s_mov_b32 s80, 0
g2_yp:
    buffer_load_ubyte v14, v1, s[56:59], s73 offen sc1
    s_waitcnt vmcnt(0)
    v_cmp_ne_u32 vcc, 0, v14
    s_add_u32 s80, s80, 1
    s_cmp_eq_u64 vcc, -1
    s_cbranch_scc1 g2_ypd
    s_cmp_lt_u32 s80, 0x40000
    s_cbranch_scc1 g2_yp
g2_ypd:
    v_mov_b32 v15, 163328
    v_mov_b32 v14, -1
    ds_write_b32 v15, v14 offset:4
g2_ypd2:
    v_lshlrev_b32 v12, 12, v1
    buffer_load_dwordx4 v[80:83], v12, s[56:59], s74 offen
g2_ydone:
    s_waitcnt vmcnt(1)
    v_fma_f32 v24, v4, v84, v85
    v_fma_f32 v25, v5, v86, v87
    v_fma_f32 v26, v6, v88, v89
    v_fma_f32 v27, v7, v90, v91
    v_fma_f32 v28, v8, v92, v93
    v_fma_f32 v29, v9, v94, v95
    v_fma_f32 v30, v10, v96, v97
    v_fma_f32 v31, v11, v98, v99
    v_cvt_pk_bf16_f32 v24, 0, v24
    v_cvt_pk_bf16_f32 v25, 0, v25
    v_cvt_pk_bf16_f32 v26, 0, v26
    v_cvt_pk_bf16_f32 v27, 0, v27
    v_cvt_pk_bf16_f32 v28, 0, v28
    v_cvt_pk_bf16_f32 v29, 0, v29
    v_cvt_pk_bf16_f32 v30, 0, v30
    v_cvt_pk_bf16_f32 v31, 0, v31
    s_add_u32 s63, s72, 4096
    s_waitcnt vmcnt(0)
    v_lshlrev_b32 v32, 16, v80
    v_and_b32 v33, 0xffff0000, v80
    v_lshlrev_b32 v34, 16, v81
    v_and_b32 v35, 0xffff0000, v81
    v_lshlrev_b32 v36, 16, v82
    v_and_b32 v37, 0xffff0000, v82
    v_lshlrev_b32 v38, 16, v83
    v_and_b32 v39, 0xffff0000, v83
    v_pk_mul_f32 v[32:33], v[32:33], v[24:25]
    v_pk_mul_f32 v[34:35], v[34:35], v[26:27]
    v_pk_mul_f32 v[36:37], v[36:37], v[28:29]
    v_pk_mul_f32 v[38:39], v[38:39], v[30:31]
    v_cvt_pk_bf16_f32 v32, 0, v32
    v_cvt_pk_bf16_f32 v33, 0, v33
    v_cvt_pk_bf16_f32 v34, 0, v34
    v_cvt_pk_bf16_f32 v35, 0, v35
    v_cvt_pk_bf16_f32 v36, 0, v36
    v_cvt_pk_bf16_f32 v37, 0, v37
    v_cvt_pk_bf16_f32 v38, 0, v38
    v_cvt_pk_bf16_f32 v39, 0, v39
    v_pk_add_f32 v[32:33], v[32:33], v[4:5]
    v_pk_add_f32 v[34:35], v[34:35], v[6:7]
    v_pk_add_f32 v[36:37], v[36:37], v[8:9]
    v_pk_add_f32 v[38:39], v[38:39], v[10:11]
    v_cvt_pk_bf16_f32 v32, 0, v32
    v_cvt_pk_bf16_f32 v33, 0, v33
    v_cvt_pk_bf16_f32 v34, 0, v34
    v_cvt_pk_bf16_f32 v35, 0, v35
    v_cvt_pk_bf16_f32 v36, 0, v36
    v_cvt_pk_bf16_f32 v37, 0, v37
    v_cvt_pk_bf16_f32 v38, 0, v38
    v_cvt_pk_bf16_f32 v39, 0, v39
    v_pk_add_f32 v[32:33], v[32:33], v[16:17]
    v_cvt_pk_bf16_f32 v32, v32, v33
    buffer_store_short v32, v3, s[48:51], s72 offen offset:0
    buffer_store_short_d16_hi v32, v3, s[48:51], s72 offen offset:1024
    v_pk_add_f32 v[34:35], v[34:35], v[18:19]
    v_cvt_pk_bf16_f32 v34, v34, v35
    buffer_store_short v34, v3, s[48:51], s72 offen offset:2048
    buffer_store_short_d16_hi v34, v3, s[48:51], s72 offen offset:3072
    v_pk_add_f32 v[36:37], v[36:37], v[20:21]
    v_cvt_pk_bf16_f32 v36, v36, v37
    buffer_store_short v36, v3, s[48:51], s63 offen offset:0
    buffer_store_short_d16_hi v36, v3, s[48:51], s63 offen offset:1024
    v_pk_add_f32 v[38:39], v[38:39], v[22:23]
    v_cvt_pk_bf16_f32 v38, v38, v39
    buffer_store_short v38, v3, s[48:51], s63 offen offset:2048
    buffer_store_short_d16_hi v38, v3, s[48:51], s63 offen offset:3072
k1_done:
    s_endpgm
g2_pol:
    v_mov_b32 v15, 163328
    ds_read_b32 v12, v15 offset:4
    s_mov_b32 s80, 0
    s_waitcnt lgkmcnt(0)
    v_readfirstlane_b32 s81, v12
    s_nop 3
    s_and_b32 s81, s81, 54525951
    s_cmp_eq_u32 s81, 54525951
    s_cbranch_scc1 g2_pol_ret
    s_cmp_lt_u32 s2, 64
    s_cbranch_scc1 g2_pol1d
g2_pol1:
    ds_read_b32 v12, v15
    s_waitcnt lgkmcnt(0)
    v_readfirstlane_b32 s81, v12
    s_add_u32 s80, s80, 1
    s_nop 2
    s_cmp_ge_i32 s81, 4
    s_cbranch_scc1 g2_pol1d
    s_sleep 2
    s_cmp_lt_u32 s80, 0x400000
    s_cbranch_scc1 g2_pol1
g2_pol1d:
    s_mov_b32 s80, 0
g2_pol2:
    buffer_load_ubyte v14, v1, s[56:59], s69 offen sc1
    s_waitcnt vmcnt(0)
    v_cmp_ne_u32 vcc, 0, v14
    s_mov_b32 s81, vcc_lo
    v_mov_b32 v12, s81
    s_mov_b64 exec, 1
    ds_or_b32 v15, v12 offset:4
    s_mov_b64 exec, -1
    s_and_b32 s81, vcc_lo, 54525951
    s_cmp_eq_u32 s81, 54525951
    s_cbranch_scc1 g2_pol_ret
    s_sleep 1
    s_add_u32 s80, s80, 1
    s_cmp_lt_u32 s80, 0x40000
    s_cbranch_scc1 g2_pol2
    v_mov_b32 v12, 0x7fffffff
    ds_or_b32 v15, v12 offset:4
    s_branch g2_pol_ret
g2_cnt:
    s_mov_b32 s80, 0
    v_mov_b32 v14, 163328
g2_cnt2:
    s_sleep 2
    ds_read_b32 v15, v14
    s_waitcnt lgkmcnt(0)
    v_readfirstlane_b32 s63, v15
    s_add_u32 s80, s80, 1
    s_nop 2
    s_cmp_ge_i32 s63, 4
    s_cbranch_scc1 g2_cnt_ret
    s_cmp_lt_u32 s80, 0x400000
    s_cbranch_scc1 g2_cnt2
    s_branch g2_cnt_ret
g2_bd:
    s_cmp_eq_u32 s42, 0
    s_cbranch_scc1 g2_bd_ret
    v_lshlrev_b32 v12, s79, v1
    v_mov_b32 v13, 1
    s_waitcnt vmcnt(0)
    s_mov_b32 exec_lo, s42
    s_mov_b32 exec_hi, 0
    buffer_store_byte v13, v12, s[56:59], s78 offen sc1
    s_mov_b64 exec, -1
    s_mov_b32 s42, 0
    s_branch g2_bd_ret
g2_nounit:
    v_lshlrev_b32 v12, s79, v1
    v_mov_b32 v13, 1
    s_waitcnt vmcnt(0)
    s_mov_b32 exec_lo, s42
    s_mov_b32 exec_hi, 0
    buffer_store_byte v13, v12, s[56:59], s78 offen sc1
    s_mov_b64 exec, -1
    s_mov_b32 s42, 0
    s_mov_b32 s44, s16
    s_and_b32 s45, s17, 0xffff
    s_mov_b32 s46, 2097152
    s_mov_b32 s47, 0x00020000
    s_mov_b32 s48, s36
    s_and_b32 s49, s37, 0xffff
    s_mov_b32 s50, 2097152
    s_mov_b32 s51, 0x00020000
    s_lshl_b32 s72, s60, 3
    s_add_u32 s72, s72, s62
    s_lshl_b32 s74, s72, 4
    s_lshl_b32 s63, s61, 18
    s_add_u32 s74, s74, s63
    s_add_u32 s74, s74, 6291456
    s_lshl_b32 s72, s72, 13
    s_lshl_b32 s63, s61, 7
    s_add_u32 s72, s72, s63
    s_add_u32 s63, s72, 4096
    v_lshlrev_b32 v3, 1, v1
    v_mov_b32 v4, 0
    v_mov_b32 v5, 0
    v_mov_b32 v6, 0
    v_mov_b32 v7, 0
    v_mov_b32 v8, 0
    v_mov_b32 v9, 0
    v_mov_b32 v10, 0
    v_mov_b32 v11, 0
    s_add_u32 s63, s72, 4096
    buffer_load_short_d16_hi v4, v3, s[44:47], s72 offen offset:0
    buffer_load_short_d16_hi v5, v3, s[44:47], s72 offen offset:1024
    buffer_load_short_d16_hi v6, v3, s[44:47], s72 offen offset:2048
    buffer_load_short_d16_hi v7, v3, s[44:47], s72 offen offset:3072
    buffer_load_short_d16_hi v8, v3, s[44:47], s63 offen offset:0
    buffer_load_short_d16_hi v9, v3, s[44:47], s63 offen offset:1024
    buffer_load_short_d16_hi v10, v3, s[44:47], s63 offen offset:2048
    buffer_load_short_d16_hi v11, v3, s[44:47], s63 offen offset:3072
    s_mov_b32 s68, 50331648
    s_mov_b32 s80, 0
poll15:
    buffer_load_ubyte v14, v1, s[56:59], s69 offen sc1
    s_waitcnt vmcnt(0)
    v_cmp_ne_u32 vcc, 0, v14
    s_add_u32 s80, s80, 1
    s_and_b32 s81, vcc_lo, s68
    s_cmp_eq_u32 s81, s68
    s_cbranch_scc1 polled15
    s_sleep 1
    s_cmp_lt_u32 s80, 0x40000
    s_cbranch_scc1 poll15
polled15:
    s_lshr_b32 s63, s72, 13
    s_lshl_b32 s63, s63, 6
    s_add_u32 s63, s63, 8388608
    buffer_load_dwordx4 v[84:87], off, s[56:59], s63 offset:0
    buffer_load_dwordx4 v[88:91], off, s[56:59], s63 offset:16
    buffer_load_dwordx4 v[92:95], off, s[56:59], s63 offset:32
    buffer_load_dwordx4 v[96:99], off, s[56:59], s63 offset:48
    s_branch g2_bar
.section .rodata,"a"
.p2align 6
.amdhsa_kernel k1_kernel
  .amdhsa_next_free_vgpr 256
  .amdhsa_next_free_sgpr 102
  .amdhsa_accum_offset 256
  .amdhsa_group_segment_fixed_size 0
  .amdhsa_kernarg_size 104
  .amdhsa_user_sgpr_count 2
  .amdhsa_user_sgpr_kernarg_segment_ptr 1
  .amdhsa_system_sgpr_workgroup_id_x 1
.end_amdhsa_kernel
```
